```python
import torch

def _softmax(x, axis=-1):
    return torch.softmax(x, dim=axis)
def _gelu(x):
    return torch.nn.functional.gelu(x, approximate="tanh")
def _silu(x):
    return torch.nn.functional.silu(x)
def _sigmoid(x):
    return torch.sigmoid(x)
def _layernorm(x, axis=-1, eps=1e-5):
    m = x.mean(dim=axis, keepdim=True)
    v = x.var(dim=axis, keepdim=True, unbiased=False)
    return (x - m) / torch.sqrt(v + eps)
def _scatter_add(tgt, idx, src, axis=0):
    return tgt.clone().index_add_(axis, idx, src)
def _segment_sum(src, seg, n):
    out = torch.zeros((n,) + src.shape[1:], dtype=src.dtype)
    return out.index_add_(0, seg, src)
def _pad(x, pw):
    flat = tuple(v for pair in reversed(pw) for v in pair)
    return torch.nn.functional.pad(x, flat)

kernel_name = 'concat_heads__ssm_conv_h3__spectral_fnet__prompt'

def setup_inputs():

    _w = (lambda a: (lambda t: t.to(torch.bfloat16) if t.is_floating_point() else t)(torch.as_tensor(a)))
    def _A_setup():
        B, S, D = 1, 2048, 1024
        ks = 4
        return {
            "q": _w((lambda *s: torch.randn(*s, dtype=torch.bfloat16) * 0.05)(B, S, D)),
            "k": _w((lambda *s: torch.randn(*s, dtype=torch.bfloat16) * 3.2)(B, S, D)),
            "v": _w((lambda *s: torch.randn(*s, dtype=torch.bfloat16) * 3.2)(B, S, D)),
            "shift_k": _w((lambda *s: torch.randn(*s, dtype=torch.bfloat16) * 3.2)(D, ks) * 0.5),
            "ssm_k": _w((lambda *s: torch.randn(*s, dtype=torch.bfloat16) * 3.2)(D, S) * (1.0 / S ** 0.5)),
            "ssm_D": _w((lambda *s: torch.randn(*s, dtype=torch.bfloat16) * 3.2)(D)),
        }
    _A_in = _A_setup()

    def _B_setup():
        B, S, D = 1, 2048, 1024
        ns = torch.arange(S)[:, None] * torch.arange(S)[None, :]
        nd = torch.arange(D)[:, None] * torch.arange(D)[None, :]
        Ws_re = torch.cos(-2.0 * torch.pi * ns / S).to(float)
        Ws_im = torch.sin(-2.0 * torch.pi * ns / S).to(float)
        Wd_re = torch.cos(-2.0 * torch.pi * nd / D).to(float)
        Wd_im = torch.sin(-2.0 * torch.pi * nd / D).to(float)
        return {
            "x": _w((lambda *s: torch.randn(*s, dtype=torch.bfloat16) * 0.05)(B, S, D)),
            "dft_seq_re": _w(Ws_re),
            "dft_seq_im": _w(Ws_im),
            "dft_hid_re": _w(Wd_re),
            "dft_hid_im": _w(Wd_im),
        }
    _B_in = _B_setup()

    return {
        "A_q": _A_in["q"],
        "A_k": _A_in["k"],
        "A_v": _A_in["v"],
        "A_shift_k": _A_in["shift_k"],
        "A_ssm_k": _A_in["ssm_k"],
        "A_ssm_D": _A_in["ssm_D"],
        "B_x": _B_in["x"],
        "B_dft_seq_re": _B_in["dft_seq_re"],
        "B_dft_seq_im": _B_in["dft_seq_im"],
        "B_dft_hid_re": _B_in["dft_hid_re"],
        "B_dft_hid_im": _B_in["dft_hid_im"],
    }

def reference(A_q, A_k, A_v, A_shift_k, A_ssm_k, A_ssm_D, B_x, B_dft_seq_re, B_dft_seq_im, B_dft_hid_re, B_dft_hid_im):
    def _A_ref(q, k, v, shift_k, ssm_k, ssm_D):
        B, S, D = q.shape
        ks = shift_k.shape[-1]
        k_pad = _pad(k, ((0, 0), (ks - 1, 0), (0, 0)))
        k_shift = torch.zeros_like(k)
        for t in range(ks):
            k_shift = k_shift + k_pad[:, t:t + S, :] * shift_k[:, ks - 1 - t][None, None, :]
        kv = k_shift * v
        L = 2 * S
        kv_pad = _pad(kv, ((0, 0), (0, S), (0, 0)))
        kf_pad = _pad(ssm_k, ((0, 0), (0, S)))
        kv_f = (lambda x, axes=(-2,-1): torch.fft.rfft2(x.float(), dim=axes))(kv_pad[:, None, :, :], axes=(1, 2))
        kf_f = (lambda x, axes=(-2,-1): torch.fft.rfft2(x.float(), dim=axes))(kf_pad[:, None, :], axes=(1, 2))
        kf_f = (lambda x, *d: x.permute(*d))(kf_f, 1, 2, 0)
        y_f = kv_f * kf_f[None, :, :, :]
        y = (lambda x, s, axes=(-2,-1): torch.fft.irfft2(x, s=s, dim=axes).to(torch.bfloat16))(y_f, (1, L), axes=(1, 2))[:, 0, :S, :]
        y = y + kv * ssm_D[None, None, :]
        return q * y

    def _B_ref(x, dft_seq_re, dft_seq_im, dft_hid_re, dft_hid_im):
        a = torch.einsum("bsd,ed->bse", x, dft_hid_re)
        b = torch.einsum("bsd,ed->bse", x, dft_hid_im)
        y = torch.einsum("ts,bse->bte", dft_seq_re, a) - torch.einsum("ts,bse->bte", dft_seq_im, b)
        return y

    a = _A_ref(A_q, A_k, A_v, A_shift_k, A_ssm_k, A_ssm_D)
    b = _B_ref(B_x, B_dft_seq_re, B_dft_seq_im, B_dft_hid_re, B_dft_hid_im)
    return torch.concatenate([a, b], axis=-1)
```

```asm
; @launch grid=(256,1,1) block=(512,1,1) lds=66880
.amdgcn_target "amdgcn-amd-amdhsa--gfx950"
.text
.globl concat_heads__ssm_conv_h3__spectral_fnet__prompt_kernel
.p2align 8
.type concat_heads__ssm_conv_h3__spectral_fnet__prompt_kernel,@function
concat_heads__ssm_conv_h3__spectral_fnet__prompt_kernel:
main_kernel:
    s_cmp_ge_u32 s2, 256
    s_cbranch_scc1 main_exit
    s_load_dwordx16 s[52:67], s[0:1], 0
    s_load_dwordx4 s[68:71], s[0:1], 88
    s_load_dwordx2 s[72:73], s[0:1], 104
    s_cmp_ge_u32 s2, 32
    s_cbranch_scc1 pf_skip
    s_getpc_b64 s[74:75]
pf_pc:
    s_sub_u32 s74, s74, pf_pc-main_kernel
    s_subb_u32 s75, s75, 0
    v_lshlrev_b32 v240, 4, v0
    v_min_u32 v241, text_end-main_kernel-16, v240
    global_load_dwordx4 v[244:247], v241, s[74:75]
    v_add_u32 v240, 8192, v240
    v_min_u32 v241, text_end-main_kernel-16, v240
    global_load_dwordx4 v[244:247], v241, s[74:75]
    v_add_u32 v240, 8192, v240
    v_min_u32 v241, text_end-main_kernel-16, v240
    global_load_dwordx4 v[244:247], v241, s[74:75]
pf_skip:
    v_lshrrev_b32 v1, 6, v0
    v_and_b32 v0, 255, v0
    s_nop 0
    v_readfirstlane_b32 s3, v1
    s_nop 3
    s_cmp_ge_u32 s3, 4
    s_cbranch_scc1 role_b
    s_setprio 1
    s_and_b32 s74, s2, 7
    s_lshr_b32 s75, s2, 3
    s_lshl_b32 s74, s74, 1
    s_lshr_b32 s76, s75, 4
    s_add_u32 s74, s74, s76
    s_and_b32 s75, s75, 15
    s_lshl_b32 s36, s75, 7
    s_lshl_b32 s37, s74, 6
    v_lshrrev_b32 v1, 4, v0
    v_and_b32 v2, 15, v0
    v_lshl_add_u32 v3, v1, 3, s36
    v_lshl_add_u32 v4, v2, 2, s37
    v_lshlrev_b32 v5, 11, v3
    v_lshl_add_u32 v5, v4, 1, v5
    v_subrev_u32 v6, 6144, v5
    v_subrev_u32 v7, 4096, v5
    v_subrev_u32 v8, 2048, v5
    v_add_u32 v9, 4096, v5
    v_add_u32 v10, 8192, v5
    v_add_u32 v11, 12288, v5
    v_lshlrev_b32 v12, 3, v4
    s_mov_b32 s6, 0x400000
    s_mov_b32 s7, 0x20000
    s_mov_b32 s10, 0x400000
    s_mov_b32 s11, 0x20000
    s_waitcnt lgkmcnt(0)
    s_mov_b32 s4, s54
    s_mov_b32 s5, s55
    s_mov_b32 s8, s56
    s_mov_b32 s9, s57
    s_or_b32 s76, s2, s3
    s_cmp_eq_u32 s76, 0
    s_cbranch_scc0 npub1
    s_memrealtime s[76:77]
    s_mov_b32 s48, s70
    s_mov_b32 s49, s71
    s_mov_b32 s50, 256
    s_mov_b32 s51, 0x20000
    v_mov_b32 v143, 0
    s_waitcnt lgkmcnt(0)
    s_or_b32 s76, s76, 1
    v_mov_b32 v142, s76
    s_mov_b64 exec, 1
    buffer_store_dword v142, v143, s[48:51], 0 offen sc1
    s_mov_b64 exec, -1
npub1:
    buffer_load_dwordx2 v[20:21], v6, s[4:7], 0 offen
    buffer_load_dwordx2 v[22:23], v7, s[4:7], 0 offen
    buffer_load_dwordx2 v[24:25], v8, s[4:7], 0 offen
    buffer_load_dwordx2 v[26:27], v5, s[4:7], 0 offen
    buffer_load_dwordx2 v[28:29], v5, s[4:7], 0 offen offset:2048
    buffer_load_dwordx2 v[30:31], v9, s[4:7], 0 offen
    buffer_load_dwordx2 v[32:33], v9, s[4:7], 0 offen offset:2048
    buffer_load_dwordx2 v[34:35], v10, s[4:7], 0 offen
    buffer_load_dwordx2 v[36:37], v10, s[4:7], 0 offen offset:2048
    buffer_load_dwordx2 v[38:39], v11, s[4:7], 0 offen
    buffer_load_dwordx2 v[40:41], v11, s[4:7], 0 offen offset:2048
    buffer_load_dwordx2 v[42:43], v5, s[8:11], 0 offen
    buffer_load_dwordx2 v[44:45], v5, s[8:11], 0 offen offset:2048
    buffer_load_dwordx2 v[46:47], v9, s[8:11], 0 offen
    buffer_load_dwordx2 v[48:49], v9, s[8:11], 0 offen offset:2048
    buffer_load_dwordx2 v[50:51], v10, s[8:11], 0 offen
    buffer_load_dwordx2 v[52:53], v10, s[8:11], 0 offen offset:2048
    buffer_load_dwordx2 v[54:55], v11, s[8:11], 0 offen
    buffer_load_dwordx2 v[56:57], v11, s[8:11], 0 offen offset:2048
    s_mov_b32 s12, s58
    s_mov_b32 s13, s59
    s_mov_b32 s14, 8192
    s_mov_b32 s15, 0x20000
    buffer_load_dwordx4 v[60:63], v12, s[12:15], 0 offen
    buffer_load_dwordx4 v[64:67], v12, s[12:15], 0 offen offset:16
    s_branch role_a_main
role_b:
    s_sub_u32 s22, s3, 4
    v_and_b32 v2, 63, v0
    s_and_b32 s16, s2, 7
    s_lshr_b32 s17, s2, 3
    s_lshl_b32 s18, s16, 2
    s_add_u32 s18, s18, s22
    s_lshl_b32 s19, s22, 12
    s_add_u32 s19, s19, 34048
    v_lshrrev_b32 v3, 2, v2
    v_and_b32 v4, 3, v2
    v_lshrrev_b32 v5, 5, v2
    v_lshlrev_b32 v5, 1, v5
    v_xor_b32 v4, v4, v5
    v_lshlrev_b32 v104, 16, v3
    v_lshl_add_u32 v104, v4, 4, v104
    s_lshl_b32 s12, s18, 11
    s_lshl_b32 s13, s17, 6
    s_add_u32 s12, s12, s13
    v_add_u32 v104, s12, v104
    s_mov_b32 s6, 0x400000
    s_mov_b32 s7, 0x20000
    s_waitcnt lgkmcnt(0)
    s_mov_b32 s4, s64
    s_mov_b32 s5, s65
    s_add_u32 m0, s19, 0
    s_mov_b32 s36, 0
    buffer_load_dwordx4 v104, s[4:7], s36 offen lds
    s_add_u32 m0, s19, 1024
    s_mov_b32 s36, 1048576
    buffer_load_dwordx4 v104, s[4:7], s36 offen lds
    s_add_u32 m0, s19, 2048
    s_mov_b32 s36, 2097152
    buffer_load_dwordx4 v104, s[4:7], s36 offen lds
    s_add_u32 m0, s19, 3072
    s_mov_b32 s36, 3145728
    buffer_load_dwordx4 v104, s[4:7], s36 offen lds
    s_cmp_eq_u32 s22, 0
    s_cbranch_scc0 init13
    v_and_b32 v7, 15, v2
    v_lshlrev_b32 v7, 2, v7
    v_add_u32 v7, 66816, v7
    v_mov_b32 v8, 0
    ds_write_b32 v7, v8
    s_waitcnt lgkmcnt(0)
init13:
    s_barrier
    s_add_u32 s8, s72, 4194304
    s_addc_u32 s9, s73, 0
    s_mov_b32 s10, 4194304
    s_mov_b32 s11, 0x20000
    s_mov_b32 s32, s68
    s_mov_b32 s33, s69
    s_mov_b32 s34, 8388608
    s_mov_b32 s35, 0x20000
    s_add_u32 s44, s72, 12582912
    s_addc_u32 s45, s73, 0
    s_mov_b32 s46, 65536
    s_mov_b32 s47, 0x20000
    v_and_b32 v7, 15, v2
    v_lshrrev_b32 v8, 4, v2
    v_lshrrev_b32 v9, 1, v7
    v_and_b32 v10, 1, v7
    v_lshlrev_b32 v11, 8, v8
    v_add_u32 v11, s18, v11
    v_cvt_f32_u32 v11, v11
    v_mul_f32 v11, 0x3a000000, v11
    v_cvt_f32_u32 v12, v10
    v_mul_f32 v12, 0x3e800000, v12
    v_add_u32 v13, 0, v9
    v_cvt_f32_u32 v13, v13
    v_cmp_eq_u32 vcc, 1, v7
    v_mov_b32 v15, 0x42000000
    s_nop 0
    v_cndmask_b32 v13, v13, v15, vcc
    v_cvt_f32_u32 v15, s18
    v_mul_f32 v15, 0xbc800000, v15
    v_cndmask_b32 v14, v12, v15, vcc
    v_fma_f32 v20, v13, v11, v14
    v_mul_f32 v17, 0x3c800000, v13
    v_cos_f32 v19, v17
    v_mul_f32 v18, 0x42000000, v17
    v_add_f32 v21, v20, v17
    v_add_f32 v28, v20, v18
    v_add_f32 v19, v19, v19
    v_cos_f32 v20, v20
    v_cos_f32 v21, v21
    s_nop 0
    v_fma_f32 v22, v19, v21, -v20
    v_fma_f32 v23, v19, v22, -v21
    v_fma_f32 v24, v19, v23, -v22
    v_fma_f32 v25, v19, v24, -v23
    v_fma_f32 v26, v19, v25, -v24
    v_fma_f32 v27, v19, v26, -v25
    v_cvt_pk_bf16_f32 v128, v20, v21
    v_cvt_pk_bf16_f32 v129, v22, v23
    v_cvt_pk_bf16_f32 v130, v24, v25
    v_cvt_pk_bf16_f32 v131, v26, v27
    v_add_f32 v21, v28, v17
    v_cos_f32 v20, v28
    v_cos_f32 v21, v21
    s_nop 0
    v_fma_f32 v22, v19, v21, -v20
    v_fma_f32 v23, v19, v22, -v21
    v_fma_f32 v24, v19, v23, -v22
    v_fma_f32 v25, v19, v24, -v23
    v_fma_f32 v26, v19, v25, -v24
    v_fma_f32 v27, v19, v26, -v25
    v_cvt_pk_bf16_f32 v132, v20, v21
    v_cvt_pk_bf16_f32 v133, v22, v23
    v_cvt_pk_bf16_f32 v134, v24, v25
    v_cvt_pk_bf16_f32 v135, v26, v27
    v_add_u32 v13, 8, v9
    v_cvt_f32_u32 v13, v13
    v_fma_f32 v20, v13, v11, v12
    v_mul_f32 v17, 0x3c800000, v13
    v_cos_f32 v19, v17
    v_mul_f32 v18, 0x42000000, v17
    v_add_f32 v21, v20, v17
    v_add_f32 v28, v20, v18
    v_add_f32 v19, v19, v19
    v_cos_f32 v20, v20
    v_cos_f32 v21, v21
    s_nop 0
    v_fma_f32 v22, v19, v21, -v20
    v_fma_f32 v23, v19, v22, -v21
    v_fma_f32 v24, v19, v23, -v22
    v_fma_f32 v25, v19, v24, -v23
    v_fma_f32 v26, v19, v25, -v24
    v_fma_f32 v27, v19, v26, -v25
    v_cvt_pk_bf16_f32 v136, v20, v21
    v_cvt_pk_bf16_f32 v137, v22, v23
    v_cvt_pk_bf16_f32 v138, v24, v25
    v_cvt_pk_bf16_f32 v139, v26, v27
    v_add_f32 v21, v28, v17
    v_cos_f32 v20, v28
    v_cos_f32 v21, v21
    s_nop 0
    v_fma_f32 v22, v19, v21, -v20
    v_fma_f32 v23, v19, v22, -v21
    v_fma_f32 v24, v19, v23, -v22
    v_fma_f32 v25, v19, v24, -v23
    v_fma_f32 v26, v19, v25, -v24
    v_fma_f32 v27, v19, v26, -v25
    v_cvt_pk_bf16_f32 v140, v20, v21
    v_cvt_pk_bf16_f32 v141, v22, v23
    v_cvt_pk_bf16_f32 v142, v24, v25
    v_cvt_pk_bf16_f32 v143, v26, v27
    v_add_u32 v13, 16, v9
    v_cvt_f32_u32 v13, v13
    v_fma_f32 v20, v13, v11, v12
    v_mul_f32 v17, 0x3c800000, v13
    v_cos_f32 v19, v17
    v_mul_f32 v18, 0x42000000, v17
    v_add_f32 v21, v20, v17
    v_add_f32 v28, v20, v18
    v_add_f32 v19, v19, v19
    v_cos_f32 v20, v20
    v_cos_f32 v21, v21
    s_nop 0
    v_fma_f32 v22, v19, v21, -v20
    v_fma_f32 v23, v19, v22, -v21
    v_fma_f32 v24, v19, v23, -v22
    v_fma_f32 v25, v19, v24, -v23
    v_fma_f32 v26, v19, v25, -v24
    v_fma_f32 v27, v19, v26, -v25
    v_cvt_pk_bf16_f32 v144, v20, v21
    v_cvt_pk_bf16_f32 v145, v22, v23
    v_cvt_pk_bf16_f32 v146, v24, v25
    v_cvt_pk_bf16_f32 v147, v26, v27
    v_add_f32 v21, v28, v17
    v_cos_f32 v20, v28
    v_cos_f32 v21, v21
    s_nop 0
    v_fma_f32 v22, v19, v21, -v20
    v_fma_f32 v23, v19, v22, -v21
    v_fma_f32 v24, v19, v23, -v22
    v_fma_f32 v25, v19, v24, -v23
    v_fma_f32 v26, v19, v25, -v24
    v_fma_f32 v27, v19, v26, -v25
    v_cvt_pk_bf16_f32 v148, v20, v21
    v_cvt_pk_bf16_f32 v149, v22, v23
    v_cvt_pk_bf16_f32 v150, v24, v25
    v_cvt_pk_bf16_f32 v151, v26, v27
    v_add_u32 v13, 24, v9
    v_cvt_f32_u32 v13, v13
    v_fma_f32 v20, v13, v11, v12
    v_mul_f32 v17, 0x3c800000, v13
    v_cos_f32 v19, v17
    v_mul_f32 v18, 0x42000000, v17
    v_add_f32 v21, v20, v17
    v_add_f32 v28, v20, v18
    v_add_f32 v19, v19, v19
    v_cos_f32 v20, v20
    v_cos_f32 v21, v21
    s_nop 0
    v_fma_f32 v22, v19, v21, -v20
    v_fma_f32 v23, v19, v22, -v21
    v_fma_f32 v24, v19, v23, -v22
    v_fma_f32 v25, v19, v24, -v23
    v_fma_f32 v26, v19, v25, -v24
    v_fma_f32 v27, v19, v26, -v25
    v_cvt_pk_bf16_f32 v152, v20, v21
    v_cvt_pk_bf16_f32 v153, v22, v23
    v_cvt_pk_bf16_f32 v154, v24, v25
    v_cvt_pk_bf16_f32 v155, v26, v27
    v_add_f32 v21, v28, v17
    v_cos_f32 v20, v28
    v_cos_f32 v21, v21
    s_nop 0
    v_fma_f32 v22, v19, v21, -v20
    v_fma_f32 v23, v19, v22, -v21
    v_fma_f32 v24, v19, v23, -v22
    v_fma_f32 v25, v19, v24, -v23
    v_fma_f32 v26, v19, v25, -v24
    v_fma_f32 v27, v19, v26, -v25
    v_cvt_pk_bf16_f32 v156, v20, v21
    v_cvt_pk_bf16_f32 v157, v22, v23
    v_cvt_pk_bf16_f32 v158, v24, v25
    v_cvt_pk_bf16_f32 v159, v26, v27
    v_lshrrev_b32 v18, 2, v7
    v_and_b32 v19, 3, v7
    v_lshl_add_u32 v18, v8, 3, v18
    v_lshlrev_b32 v18, 6, v18
    v_lshl_add_u32 v18, v19, 3, v18
    v_add_u32 v18, s19, v18
    v_and_b32 v19, 1, v8
    v_lshlrev_b32 v19, 5, v19
    v_add_u32 v105, v18, v19
    v_xor_b32 v19, 32, v19
    v_add_u32 v106, v18, v19
    v_lshlrev_b32 v107, 6, v8
    v_add_u32 v107, v107, v7
    v_lshlrev_b32 v107, 4, v107
    s_lshl_b32 s12, s22, 2
    s_add_u32 s12, s12, 50432
    v_add_u32 v107, s12, v107
    v_lshlrev_b32 v108, 4, v0
    v_add_u32 v108, 50432, v108
    v_lshrrev_b32 v109, 5, v0
    v_lshlrev_b32 v109, 17, v109
    v_and_b32 v20, 31, v0
    v_lshl_add_u32 v109, v20, 4, v109
    s_lshl_b32 s12, s16, 14
    s_lshl_b32 s13, s17, 9
    s_add_u32 s12, s12, s13
    v_add_u32 v109, s12, v109
    s_and_b32 s14, s2, 7
    s_lshr_b32 s15, s2, 3
    s_lshl_b32 s14, s14, 1
    s_lshr_b32 s12, s15, 4
    s_add_u32 s14, s14, s12
    s_and_b32 s15, s15, 15
    s_and_b32 s20, s2, 7
    s_lshr_b32 s21, s2, 6
    s_lshl_b32 s21, s21, 3
    s_add_u32 s20, s20, s21
    s_lshr_b32 s21, s2, 3
    s_and_b32 s21, s21, 7
    v_and_b32 v3, 15, v2
    v_lshrrev_b32 v4, 4, v2
    v_lshlrev_b32 v5, 14, v4
    v_lshl_add_u32 v5, v3, 4, v5
    s_lshl_b32 s23, s20, 17
    s_lshl_b32 s24, s22, 12
    s_add_u32 s23, s23, s24
    v_add_u32 v5, s23, v5
    v_add_u32 v6, 0x10000, v5
    s_waitcnt vmcnt(0)
    ds_read_b64_tr_b16 v[160:161], v105 offset:0
    ds_read_b64_tr_b16 v[162:163], v105 offset:256
    ds_read_b64_tr_b16 v[164:165], v105 offset:2048
    ds_read_b64_tr_b16 v[166:167], v105 offset:2304
    ds_read_b64_tr_b16 v[168:169], v106 offset:0
    ds_read_b64_tr_b16 v[170:171], v106 offset:256
    ds_read_b64_tr_b16 v[172:173], v106 offset:2048
    ds_read_b64_tr_b16 v[174:175], v106 offset:2304
    s_waitcnt lgkmcnt(0)
    v_mfma_f32_16x16x32_bf16 v[176:179], v[128:131], v[160:163], 0
    v_mfma_f32_16x16x32_bf16 v[180:183], v[128:131], v[168:171], 0
    v_mfma_f32_16x16x32_bf16 v[184:187], v[136:139], v[160:163], 0
    v_mfma_f32_16x16x32_bf16 v[188:191], v[136:139], v[168:171], 0
    v_mfma_f32_16x16x32_bf16 v[192:195], v[144:147], v[160:163], 0
    v_mfma_f32_16x16x32_bf16 v[196:199], v[144:147], v[168:171], 0
    v_mfma_f32_16x16x32_bf16 v[200:203], v[152:155], v[160:163], 0
    v_mfma_f32_16x16x32_bf16 v[204:207], v[152:155], v[168:171], 0
    v_mfma_f32_16x16x32_bf16 v[176:179], v[132:135], v[164:167], v[176:179]
    v_mfma_f32_16x16x32_bf16 v[180:183], v[132:135], v[172:175], v[180:183]
    v_mfma_f32_16x16x32_bf16 v[184:187], v[140:143], v[164:167], v[184:187]
    v_mfma_f32_16x16x32_bf16 v[188:191], v[140:143], v[172:175], v[188:191]
    v_mfma_f32_16x16x32_bf16 v[192:195], v[148:151], v[164:167], v[192:195]
    v_mfma_f32_16x16x32_bf16 v[196:199], v[148:151], v[172:175], v[196:199]
    v_mfma_f32_16x16x32_bf16 v[200:203], v[156:159], v[164:167], v[200:203]
    v_mfma_f32_16x16x32_bf16 v[204:207], v[156:159], v[172:175], v[204:207]
    s_nop 0
    v_cvt_pk_bf16_f32 v110, v176, v177
    v_cvt_pk_bf16_f32 v111, v178, v179
    ds_write_b32 v107, v110 offset:0
    ds_write_b32 v107, v111 offset:512
    v_cvt_pk_bf16_f32 v112, v180, v181
    v_cvt_pk_bf16_f32 v113, v182, v183
    ds_write_b32 v107, v112 offset:256
    ds_write_b32 v107, v113 offset:768
    v_cvt_pk_bf16_f32 v114, v184, v185
    v_cvt_pk_bf16_f32 v115, v186, v187
    ds_write_b32 v107, v114 offset:4096
    ds_write_b32 v107, v115 offset:4608
    v_cvt_pk_bf16_f32 v116, v188, v189
    v_cvt_pk_bf16_f32 v117, v190, v191
    ds_write_b32 v107, v116 offset:4352
    ds_write_b32 v107, v117 offset:4864
    v_cvt_pk_bf16_f32 v110, v192, v193
    v_cvt_pk_bf16_f32 v111, v194, v195
    ds_write_b32 v107, v110 offset:8192
    ds_write_b32 v107, v111 offset:8704
    v_cvt_pk_bf16_f32 v112, v196, v197
    v_cvt_pk_bf16_f32 v113, v198, v199
    ds_write_b32 v107, v112 offset:8448
    ds_write_b32 v107, v113 offset:8960
    v_cvt_pk_bf16_f32 v114, v200, v201
    v_cvt_pk_bf16_f32 v115, v202, v203
    ds_write_b32 v107, v114 offset:12288
    ds_write_b32 v107, v115 offset:12800
    v_cvt_pk_bf16_f32 v116, v204, v205
    v_cvt_pk_bf16_f32 v117, v206, v207
    ds_write_b32 v107, v116 offset:12544
    ds_write_b32 v107, v117 offset:13056
    v_mov_b32 v118, 66848
    v_mov_b32 v119, 1
    s_waitcnt lgkmcnt(0)
    s_mov_b64 exec, 1
    ds_add_u32 v118, v119
    s_mov_b64 exec, -1
    v_mov_b32 v118, 66848
    s_mov_b32 s13, 0
spin14:
    ds_read_b32 v119, v118
    s_waitcnt lgkmcnt(0)
    v_readfirstlane_b32 s12, v119
    s_add_u32 s13, s13, 1
    s_cmp_gt_u32 s13, 0x1000000
    s_cbranch_scc1 spin14_ok
    s_nop 0
    s_cmp_ge_u32 s12, 4
    s_cbranch_scc1 spin14_ok
    s_sleep 1
    s_branch spin14
spin14_ok:
    ds_read_b128 v[208:211], v108 offset:0
    ds_read_b128 v[212:215], v108 offset:4096
    ds_read_b128 v[216:219], v108 offset:8192
    ds_read_b128 v[220:223], v108 offset:12288
    s_mov_b32 s36, 0
    s_waitcnt lgkmcnt(3)
    buffer_store_dwordx4 v[208:211], v109, s[8:11], s36 offen sc1
    s_mov_b32 s36, 1048576
    s_waitcnt lgkmcnt(2)
    buffer_store_dwordx4 v[212:215], v109, s[8:11], s36 offen sc1
    s_mov_b32 s36, 2097152
    s_waitcnt lgkmcnt(1)
    buffer_store_dwordx4 v[216:219], v109, s[8:11], s36 offen sc1
    s_mov_b32 s36, 3145728
    s_waitcnt lgkmcnt(0)
    buffer_store_dwordx4 v[220:223], v109, s[8:11], s36 offen sc1
    v_mov_b32 v118, 66816
    s_mov_b32 s13, 0
spin15:
    ds_read_b32 v119, v118
    s_waitcnt lgkmcnt(0)
    v_readfirstlane_b32 s12, v119
    s_add_u32 s13, s13, 1
    s_cmp_gt_u32 s13, 0x1000000
    s_cbranch_scc1 spin15_ok
    s_nop 0
    s_cmp_ge_u32 s12, 1
    s_cbranch_scc1 spin15_ok
    s_sleep 1
    s_branch spin15
spin15_ok:
    v_mov_b32 v122, v119
    s_waitcnt vmcnt(0)
    v_mov_b32 v118, 66824
    v_mov_b32 v119, 1
    s_mov_b64 exec, 1
    ds_add_rtn_u32 v119, v118, v119
    s_waitcnt lgkmcnt(0)
    s_mov_b64 exec, -1
    v_readfirstlane_b32 s12, v119
    s_nop 3
    s_cmp_eq_u32 s12, 3
    s_cbranch_scc0 b1sig16
    s_lshl_b32 s12, s14, 8
    s_lshl_b32 s13, s15, 2
    s_add_u32 s12, s12, s13
    s_add_u32 s12, s12, 8192
    v_mov_b32 v118, s12
    v_add_u32 v119, 24576, v118
    s_mov_b64 exec, 1
    buffer_store_dword v122, v119, s[44:47], 0 offen
    buffer_store_dword v122, v118, s[44:47], 0 offen sc1
    s_mov_b64 exec, -1
b1sig16:
    s_or_b32 s12, s15, s22
    s_cmp_eq_u32 s12, 0
    s_cbranch_scc0 lead17
    s_lshl_b32 s12, s14, 8
    s_add_u32 s12, s12, 32768
    v_lshlrev_b32 v123, 2, v3
    v_add_u32 v123, s12, v123
    s_mov_b32 s16, 0
pt18:
    buffer_load_dword v124, v123, s[44:47], 0 offen nt
    s_waitcnt vmcnt(0)
    v_cmp_ne_u32 vcc, v124, v122
    s_nop 4
    s_cbranch_vccz pt18_ok
    s_add_u32 s16, s16, 1
    s_and_b32 s17, s16, 3
    s_cmp_eq_u32 s17, 0
    s_cbranch_scc1 pt18_glob
    s_sleep 1
    s_branch pt18
pt18_glob:
    s_cmp_gt_u32 s16, 0x80000
    s_cbranch_scc1 pt18_ok
    v_subrev_u32 v125, 24576, v123
    buffer_load_dword v124, v125, s[44:47], 0 offen sc1
    s_waitcnt vmcnt(0)
    v_cmp_ne_u32 vcc, v124, v122
    s_nop 4
    s_cbranch_vccnz pt18
pt18_ok:
    v_and_b32 v123, 7, v2
    v_lshlrev_b32 v123, 8, v123
    s_lshl_b32 s12, s14, 2
    s_add_u32 s12, s12, 12288
    v_add_u32 v123, s12, v123
    s_mov_b64 exec, 0xff
    buffer_store_dword v122, v123, s[44:47], 0 offen sc1
    s_mov_b64 exec, -1
lead17:
    v_lshrrev_b32 v7, 1, v3
    v_and_b32 v8, 1, v3
    s_lshl_b32 s25, s21, 2
    s_cmp_eq_u32 s20, 0
    s_cselect_b32 s26, 1, 0
    s_cmp_ge_u32 s21, 4
    s_cselect_b32 s27, s26, 0
    s_cmp_eq_u32 s21, 0
    s_cselect_b32 s28, s26, 0
    s_and_b32 s29, s25, 15
    s_cmp_eq_u32 s27, 1
    s_cselect_b32 s25, s29, s25
    v_add_u32 v9, s25, v7
    v_cmp_eq_u32 vcc, 4, v7
    v_mov_b32 v10, 16
    s_nop 0
    v_cndmask_b32 v9, v9, v10, vcc
    v_cvt_f32_u32 v9, v9
    v_mul_f32 v9, 0x3d000000, v9
    v_mov_b32 v10, 0x3c800000
    s_cmp_eq_u32 s27, 1
    s_cselect_b32 s30, 1.0, 0
    v_fma_f32 v9, s30, v10, v9
    v_cvt_f32_u32 v10, v8
    v_mul_f32 v10, 0x3e800000, v10
    s_cselect_b32 s31, 0, 0xbe800000
    v_add_f32 v11, s31, v10
    s_lshl_b32 s29, s28, 1
    s_add_u32 s29, s29, 8
    v_cmp_gt_u32 vcc, s29, v3
    s_nop 1
    v_cndmask_b32 v12, 0, 1.0, vcc
    s_cmp_eq_u32 s27, 1
    s_cselect_b32 s30, 0, 1.0
    v_mul_f32 v13, s30, v12
    s_sub_u32 s29, s26, s27
    s_cmp_eq_u32 s29, 1
    s_cselect_b32 s30, 0, 1.0
    v_mul_f32 v14, s30, v12
    v_lshlrev_b32 v15, 2, v4
    v_cvt_f32_u32 v15, v15
    v_add_f32 v24, 0x0, v15
    v_fma_f32 v24, v24, v9, v10
    v_add_f32 v25, 0x0, v15
    v_fma_f32 v25, v25, v9, v11
    v_add_f32 v26, 0x3f800000, v15
    v_fma_f32 v26, v26, v9, v10
    v_add_f32 v27, 0x3f800000, v15
    v_fma_f32 v27, v27, v9, v11
    v_add_f32 v28, 0x40000000, v15
    v_fma_f32 v28, v28, v9, v10
    v_add_f32 v29, 0x40000000, v15
    v_fma_f32 v29, v29, v9, v11
    v_add_f32 v30, 0x40400000, v15
    v_fma_f32 v30, v30, v9, v10
    v_add_f32 v31, 0x40400000, v15
    v_fma_f32 v31, v31, v9, v11
    v_cos_f32 v24, v24
    v_cos_f32 v25, v25
    v_cos_f32 v26, v26
    v_cos_f32 v27, v27
    v_cos_f32 v28, v28
    v_cos_f32 v29, v29
    v_cos_f32 v30, v30
    v_cos_f32 v31, v31
    v_mul_f32 v24, v24, v13
    v_mul_f32 v25, v25, v14
    v_mul_f32 v26, v26, v13
    v_mul_f32 v27, v27, v14
    v_mul_f32 v28, v28, v13
    v_mul_f32 v29, v29, v14
    v_mul_f32 v30, v30, v13
    v_mul_f32 v31, v31, v14
    v_cvt_pk_bf16_f32 v16, v24, v25
    v_cvt_pk_bf16_f32 v17, v26, v27
    v_cvt_pk_bf16_f32 v18, v28, v29
    v_cvt_pk_bf16_f32 v19, v30, v31
    v_add_f32 v24, 0x41800000, v15
    v_fma_f32 v24, v24, v9, v10
    v_add_f32 v25, 0x41800000, v15
    v_fma_f32 v25, v25, v9, v11
    v_add_f32 v26, 0x41880000, v15
    v_fma_f32 v26, v26, v9, v10
    v_add_f32 v27, 0x41880000, v15
    v_fma_f32 v27, v27, v9, v11
    v_add_f32 v28, 0x41900000, v15
    v_fma_f32 v28, v28, v9, v10
    v_add_f32 v29, 0x41900000, v15
    v_fma_f32 v29, v29, v9, v11
    v_add_f32 v30, 0x41980000, v15
    v_fma_f32 v30, v30, v9, v10
    v_add_f32 v31, 0x41980000, v15
    v_fma_f32 v31, v31, v9, v11
    v_cos_f32 v24, v24
    v_cos_f32 v25, v25
    v_cos_f32 v26, v26
    v_cos_f32 v27, v27
    v_cos_f32 v28, v28
    v_cos_f32 v29, v29
    v_cos_f32 v30, v30
    v_cos_f32 v31, v31
    v_mul_f32 v24, v24, v13
    v_mul_f32 v25, v25, v14
    v_mul_f32 v26, v26, v13
    v_mul_f32 v27, v27, v14
    v_mul_f32 v28, v28, v13
    v_mul_f32 v29, v29, v14
    v_mul_f32 v30, v30, v13
    v_mul_f32 v31, v31, v14
    v_cvt_pk_bf16_f32 v20, v24, v25
    v_cvt_pk_bf16_f32 v21, v26, v27
    v_cvt_pk_bf16_f32 v22, v28, v29
    v_cvt_pk_bf16_f32 v23, v30, v31
    v_and_b32 v32, 31, v2
    v_lshrrev_b32 v33, 5, v2
    v_cvt_f32_u32 v34, v32
    v_lshlrev_b32 v35, 2, v33
    v_cvt_f32_u32 v35, v35
    v_mul_f32 v36, 0x3d000000, v34
    v_mul_f32 v37, 0x3a800000, v34
    v_add_f32 v24, 0x0, v35
    v_mul_f32 v24, v24, v36
    v_add_f32 v25, 0x3f800000, v35
    v_mul_f32 v25, v25, v36
    v_add_f32 v26, 0x40000000, v35
    v_mul_f32 v26, v26, v36
    v_add_f32 v27, 0x40400000, v35
    v_mul_f32 v27, v27, v36
    v_add_f32 v28, 0x41000000, v35
    v_mul_f32 v28, v28, v36
    v_add_f32 v29, 0x41100000, v35
    v_mul_f32 v29, v29, v36
    v_add_f32 v30, 0x41200000, v35
    v_mul_f32 v30, v30, v36
    v_add_f32 v31, 0x41300000, v35
    v_mul_f32 v31, v31, v36
    v_sin_f32 v72, v24
    v_sin_f32 v73, v25
    v_sin_f32 v74, v26
    v_sin_f32 v75, v27
    v_sin_f32 v76, v28
    v_sin_f32 v77, v29
    v_sin_f32 v78, v30
    v_sin_f32 v79, v31
    v_cos_f32 v24, v24
    v_cos_f32 v25, v25
    v_cos_f32 v26, v26
    v_cos_f32 v27, v27
    v_cos_f32 v28, v28
    v_cos_f32 v29, v29
    v_cos_f32 v30, v30
    v_cos_f32 v31, v31
    v_cvt_pk_bf16_f32 v40, v24, v25
    v_cvt_pk_bf16_f32 v48, v72, v73
    v_cvt_pk_bf16_f32 v41, v26, v27
    v_cvt_pk_bf16_f32 v49, v74, v75
    v_cvt_pk_bf16_f32 v42, v28, v29
    v_cvt_pk_bf16_f32 v50, v76, v77
    v_cvt_pk_bf16_f32 v43, v30, v31
    v_cvt_pk_bf16_f32 v51, v78, v79
    v_add_f32 v24, 0x41800000, v35
    v_mul_f32 v24, v24, v36
    v_add_f32 v25, 0x41880000, v35
    v_mul_f32 v25, v25, v36
    v_add_f32 v26, 0x41900000, v35
    v_mul_f32 v26, v26, v36
    v_add_f32 v27, 0x41980000, v35
    v_mul_f32 v27, v27, v36
    v_add_f32 v28, 0x41c00000, v35
    v_mul_f32 v28, v28, v36
    v_add_f32 v29, 0x41c80000, v35
    v_mul_f32 v29, v29, v36
    v_add_f32 v30, 0x41d00000, v35
    v_mul_f32 v30, v30, v36
    v_add_f32 v31, 0x41d80000, v35
    v_mul_f32 v31, v31, v36
    v_sin_f32 v72, v24
    v_sin_f32 v73, v25
    v_sin_f32 v74, v26
    v_sin_f32 v75, v27
    v_sin_f32 v76, v28
    v_sin_f32 v77, v29
    v_sin_f32 v78, v30
    v_sin_f32 v79, v31
    v_cos_f32 v24, v24
    v_cos_f32 v25, v25
    v_cos_f32 v26, v26
    v_cos_f32 v27, v27
    v_cos_f32 v28, v28
    v_cos_f32 v29, v29
    v_cos_f32 v30, v30
    v_cos_f32 v31, v31
    v_cvt_pk_bf16_f32 v44, v24, v25
    v_cvt_pk_bf16_f32 v52, v72, v73
    v_cvt_pk_bf16_f32 v45, v26, v27
    v_cvt_pk_bf16_f32 v53, v74, v75
    v_cvt_pk_bf16_f32 v46, v28, v29
    v_cvt_pk_bf16_f32 v54, v76, v77
    v_cvt_pk_bf16_f32 v47, v30, v31
    v_cvt_pk_bf16_f32 v55, v78, v79
    v_xor_b32 v56, 0x80008000, v48
    v_xor_b32 v64, 0x80008000, v40
    v_xor_b32 v57, 0x80008000, v49
    v_xor_b32 v65, 0x80008000, v41
    v_xor_b32 v58, 0x80008000, v50
    v_xor_b32 v66, 0x80008000, v42
    v_xor_b32 v59, 0x80008000, v51
    v_xor_b32 v67, 0x80008000, v43
    v_xor_b32 v60, 0x80008000, v52
    v_xor_b32 v68, 0x80008000, v44
    v_xor_b32 v61, 0x80008000, v53
    v_xor_b32 v69, 0x80008000, v45
    v_xor_b32 v62, 0x80008000, v54
    v_xor_b32 v70, 0x80008000, v46
    v_xor_b32 v63, 0x80008000, v55
    v_xor_b32 v71, 0x80008000, v47
    v_add_f32 v72, 0x0, v35
    v_mul_f32 v72, v72, v37
    v_add_f32 v73, 0x3f800000, v35
    v_mul_f32 v73, v73, v37
    v_add_f32 v74, 0x40000000, v35
    v_mul_f32 v74, v74, v37
    v_add_f32 v75, 0x40400000, v35
    v_mul_f32 v75, v75, v37
    v_add_f32 v76, 0x41000000, v35
    v_mul_f32 v76, v76, v37
    v_add_f32 v77, 0x41100000, v35
    v_mul_f32 v77, v77, v37
    v_add_f32 v78, 0x41200000, v35
    v_mul_f32 v78, v78, v37
    v_add_f32 v79, 0x41300000, v35
    v_mul_f32 v79, v79, v37
    v_add_f32 v80, 0x41800000, v35
    v_mul_f32 v80, v80, v37
    v_add_f32 v81, 0x41880000, v35
    v_mul_f32 v81, v81, v37
    v_add_f32 v82, 0x41900000, v35
    v_mul_f32 v82, v82, v37
    v_add_f32 v83, 0x41980000, v35
    v_mul_f32 v83, v83, v37
    v_add_f32 v84, 0x41c00000, v35
    v_mul_f32 v84, v84, v37
    v_add_f32 v85, 0x41c80000, v35
    v_mul_f32 v85, v85, v37
    v_add_f32 v86, 0x41d00000, v35
    v_mul_f32 v86, v86, v37
    v_add_f32 v87, 0x41d80000, v35
    v_mul_f32 v87, v87, v37
    v_sin_f32 v88, v72
    v_sin_f32 v89, v73
    v_sin_f32 v90, v74
    v_sin_f32 v91, v75
    v_sin_f32 v92, v76
    v_sin_f32 v93, v77
    v_sin_f32 v94, v78
    v_sin_f32 v95, v79
    v_sin_f32 v96, v80
    v_sin_f32 v97, v81
    v_sin_f32 v98, v82
    v_sin_f32 v99, v83
    v_sin_f32 v100, v84
    v_sin_f32 v101, v85
    v_sin_f32 v102, v86
    v_sin_f32 v103, v87
    v_cos_f32 v72, v72
    v_cos_f32 v73, v73
    v_cos_f32 v74, v74
    v_cos_f32 v75, v75
    v_cos_f32 v76, v76
    v_cos_f32 v77, v77
    v_cos_f32 v78, v78
    v_cos_f32 v79, v79
    v_cos_f32 v80, v80
    v_cos_f32 v81, v81
    v_cos_f32 v82, v82
    v_cos_f32 v83, v83
    v_cos_f32 v84, v84
    v_cos_f32 v85, v85
    v_cos_f32 v86, v86
    v_cos_f32 v87, v87
    v_min_u32 v24, 10, v3
    v_mul_u32_u24 v24, 2056, v24
    v_lshl_add_u32 v24, v4, 3, v24
    s_lshl_b32 s29, s22, 9
    s_add_u32 s29, s29, 34048
    v_add_u32 v24, s29, v24
    s_and_b32 s12, s2, 7
    s_lshl_b32 s12, s12, 8
    s_add_u32 s12, s12, 12288
    v_lshlrev_b32 v123, 2, v3
    v_add_u32 v123, s12, v123
    s_cmp_eq_u32 s22, 0
    s_cbranch_scc0 wp19_spin
    s_mov_b32 s16, 0
poll20:
    buffer_load_dword v124, v123, s[44:47], 0 offen sc1
    s_waitcnt vmcnt(0)
    v_cmp_ne_u32 vcc, v124, v122
    s_nop 4
    s_cbranch_vccz poll20_ok
    s_add_u32 s16, s16, 1
    s_cmp_gt_u32 s16, 0x80000
    s_cbranch_scc1 poll20_ok
    s_sleep 1
    s_branch poll20
poll20_ok:
    v_mov_b32 v124, 66844
    v_mov_b32 v125, 1
    ds_write_b32 v124, v125
    s_branch wp19_done
wp19_spin:
    v_mov_b32 v124, 66844
    s_mov_b32 s17, 0
spin21:
    ds_read_b32 v125, v124
    s_waitcnt lgkmcnt(0)
    v_readfirstlane_b32 s16, v125
    s_add_u32 s17, s17, 1
    s_cmp_gt_u32 s17, 0x1000000
    s_cbranch_scc1 spin21_ok
    s_nop 0
    s_cmp_ge_u32 s16, 1
    s_cbranch_scc1 spin21_ok
    s_sleep 1
    s_branch spin21
spin21_ok:
wp19_done:
    s_setprio 0
    buffer_load_dwordx4 v[128:131], v5, s[8:11], 0 offen offset:0 sc1
    buffer_load_dwordx4 v[132:135], v6, s[8:11], 0 offen offset:0 sc1
    buffer_load_dwordx4 v[136:139], v5, s[8:11], 0 offen offset:256 sc1
    buffer_load_dwordx4 v[140:143], v6, s[8:11], 0 offen offset:256 sc1
    buffer_load_dwordx4 v[144:147], v5, s[8:11], 0 offen offset:512 sc1
    buffer_load_dwordx4 v[148:151], v6, s[8:11], 0 offen offset:512 sc1
    buffer_load_dwordx4 v[152:155], v5, s[8:11], 0 offen offset:768 sc1
    buffer_load_dwordx4 v[156:159], v6, s[8:11], 0 offen offset:768 sc1
    buffer_load_dwordx4 v[160:163], v5, s[8:11], 0 offen offset:1024 sc1
    buffer_load_dwordx4 v[164:167], v6, s[8:11], 0 offen offset:1024 sc1
    buffer_load_dwordx4 v[168:171], v5, s[8:11], 0 offen offset:1280 sc1
    buffer_load_dwordx4 v[172:175], v6, s[8:11], 0 offen offset:1280 sc1
    buffer_load_dwordx4 v[176:179], v5, s[8:11], 0 offen offset:1536 sc1
    buffer_load_dwordx4 v[180:183], v6, s[8:11], 0 offen offset:1536 sc1
    buffer_load_dwordx4 v[184:187], v5, s[8:11], 0 offen offset:1792 sc1
    buffer_load_dwordx4 v[188:191], v6, s[8:11], 0 offen offset:1792 sc1
    buffer_load_dwordx4 v[192:195], v5, s[8:11], 0 offen offset:2048 sc1
    buffer_load_dwordx4 v[196:199], v6, s[8:11], 0 offen offset:2048 sc1
    buffer_load_dwordx4 v[200:203], v5, s[8:11], 0 offen offset:2304 sc1
    buffer_load_dwordx4 v[204:207], v6, s[8:11], 0 offen offset:2304 sc1
    buffer_load_dwordx4 v[208:211], v5, s[8:11], 0 offen offset:2560 sc1
    buffer_load_dwordx4 v[212:215], v6, s[8:11], 0 offen offset:2560 sc1
    buffer_load_dwordx4 v[216:219], v5, s[8:11], 0 offen offset:2816 sc1
    buffer_load_dwordx4 v[220:223], v6, s[8:11], 0 offen offset:2816 sc1
    buffer_load_dwordx4 v[224:227], v5, s[8:11], 0 offen offset:3072 sc1
    buffer_load_dwordx4 v[228:231], v6, s[8:11], 0 offen offset:3072 sc1
    buffer_load_dwordx4 v[232:235], v5, s[8:11], 0 offen offset:3328 sc1
    buffer_load_dwordx4 v[236:239], v6, s[8:11], 0 offen offset:3328 sc1
    buffer_load_dwordx4 v[240:243], v5, s[8:11], 0 offen offset:3584 sc1
    buffer_load_dwordx4 v[244:247], v6, s[8:11], 0 offen offset:3584 sc1
    buffer_load_dwordx4 v[248:251], v5, s[8:11], 0 offen offset:3840 sc1
    buffer_load_dwordx4 v[252:255], v6, s[8:11], 0 offen offset:3840 sc1
    s_waitcnt vmcnt(30)
    v_mfma_f32_16x16x32_bf16 v[104:107], v[128:131], v[16:19], 0
    v_mfma_f32_16x16x32_bf16 v[104:107], v[132:135], v[20:23], v[104:107]
    s_waitcnt vmcnt(28)
    v_mfma_f32_16x16x32_bf16 v[108:111], v[136:139], v[16:19], 0
    v_mfma_f32_16x16x32_bf16 v[108:111], v[140:143], v[20:23], v[108:111]
    s_waitcnt vmcnt(26)
    v_mfma_f32_16x16x32_bf16 v[112:115], v[144:147], v[16:19], 0
    v_mfma_f32_16x16x32_bf16 v[112:115], v[148:151], v[20:23], v[112:115]
    s_nop 1
    v_cvt_pk_bf16_f32 v120, v104, v105
    v_cvt_pk_bf16_f32 v121, v106, v107
    ds_write_b64 v24, v[120:121] offset:0
    s_waitcnt vmcnt(24)
    v_mfma_f32_16x16x32_bf16 v[116:119], v[152:155], v[16:19], 0
    v_mfma_f32_16x16x32_bf16 v[116:119], v[156:159], v[20:23], v[116:119]
    v_cvt_pk_bf16_f32 v126, v108, v109
    v_cvt_pk_bf16_f32 v127, v110, v111
    ds_write_b64 v24, v[126:127] offset:32
    s_waitcnt vmcnt(22)
    v_mfma_f32_16x16x32_bf16 v[104:107], v[160:163], v[16:19], 0
    v_mfma_f32_16x16x32_bf16 v[104:107], v[164:167], v[20:23], v[104:107]
    v_cvt_pk_bf16_f32 v120, v112, v113
    v_cvt_pk_bf16_f32 v121, v114, v115
    ds_write_b64 v24, v[120:121] offset:64
    s_waitcnt vmcnt(20)
    v_mfma_f32_16x16x32_bf16 v[108:111], v[168:171], v[16:19], 0
    v_mfma_f32_16x16x32_bf16 v[108:111], v[172:175], v[20:23], v[108:111]
    v_cvt_pk_bf16_f32 v126, v116, v117
    v_cvt_pk_bf16_f32 v127, v118, v119
    ds_write_b64 v24, v[126:127] offset:96
    s_waitcnt vmcnt(18)
    v_mfma_f32_16x16x32_bf16 v[112:115], v[176:179], v[16:19], 0
    v_mfma_f32_16x16x32_bf16 v[112:115], v[180:183], v[20:23], v[112:115]
    v_cvt_pk_bf16_f32 v120, v104, v105
    v_cvt_pk_bf16_f32 v121, v106, v107
    ds_write_b64 v24, v[120:121] offset:128
    s_waitcnt vmcnt(16)
    v_mfma_f32_16x16x32_bf16 v[116:119], v[184:187], v[16:19], 0
    v_mfma_f32_16x16x32_bf16 v[116:119], v[188:191], v[20:23], v[116:119]
    v_cvt_pk_bf16_f32 v126, v108, v109
    v_cvt_pk_bf16_f32 v127, v110, v111
    ds_write_b64 v24, v[126:127] offset:160
    s_waitcnt vmcnt(14)
    v_mfma_f32_16x16x32_bf16 v[104:107], v[192:195], v[16:19], 0
    v_mfma_f32_16x16x32_bf16 v[104:107], v[196:199], v[20:23], v[104:107]
    v_cvt_pk_bf16_f32 v120, v112, v113
    v_cvt_pk_bf16_f32 v121, v114, v115
    ds_write_b64 v24, v[120:121] offset:192
    s_waitcnt vmcnt(12)
    v_mfma_f32_16x16x32_bf16 v[108:111], v[200:203], v[16:19], 0
    v_mfma_f32_16x16x32_bf16 v[108:111], v[204:207], v[20:23], v[108:111]
    v_cvt_pk_bf16_f32 v126, v116, v117
    v_cvt_pk_bf16_f32 v127, v118, v119
    ds_write_b64 v24, v[126:127] offset:224
    s_waitcnt vmcnt(10)
    v_mfma_f32_16x16x32_bf16 v[112:115], v[208:211], v[16:19], 0
    v_mfma_f32_16x16x32_bf16 v[112:115], v[212:215], v[20:23], v[112:115]
    v_cvt_pk_bf16_f32 v120, v104, v105
    v_cvt_pk_bf16_f32 v121, v106, v107
    ds_write_b64 v24, v[120:121] offset:256
    s_waitcnt vmcnt(8)
    v_mfma_f32_16x16x32_bf16 v[116:119], v[216:219], v[16:19], 0
    v_mfma_f32_16x16x32_bf16 v[116:119], v[220:223], v[20:23], v[116:119]
    v_cvt_pk_bf16_f32 v126, v108, v109
    v_cvt_pk_bf16_f32 v127, v110, v111
    ds_write_b64 v24, v[126:127] offset:288
    s_waitcnt vmcnt(6)
    v_mfma_f32_16x16x32_bf16 v[104:107], v[224:227], v[16:19], 0
    v_mfma_f32_16x16x32_bf16 v[104:107], v[228:231], v[20:23], v[104:107]
    v_cvt_pk_bf16_f32 v120, v112, v113
    v_cvt_pk_bf16_f32 v121, v114, v115
    ds_write_b64 v24, v[120:121] offset:320
    s_waitcnt vmcnt(4)
    v_mfma_f32_16x16x32_bf16 v[108:111], v[232:235], v[16:19], 0
    v_mfma_f32_16x16x32_bf16 v[108:111], v[236:239], v[20:23], v[108:111]
    v_cvt_pk_bf16_f32 v126, v116, v117
    v_cvt_pk_bf16_f32 v127, v118, v119
    ds_write_b64 v24, v[126:127] offset:352
    s_waitcnt vmcnt(2)
    v_mfma_f32_16x16x32_bf16 v[112:115], v[240:243], v[16:19], 0
    v_mfma_f32_16x16x32_bf16 v[112:115], v[244:247], v[20:23], v[112:115]
    v_cvt_pk_bf16_f32 v120, v104, v105
    v_cvt_pk_bf16_f32 v121, v106, v107
    ds_write_b64 v24, v[120:121] offset:384
    s_waitcnt vmcnt(0)
    v_mfma_f32_16x16x32_bf16 v[116:119], v[248:251], v[16:19], 0
    v_mfma_f32_16x16x32_bf16 v[116:119], v[252:255], v[20:23], v[116:119]
    v_cvt_pk_bf16_f32 v126, v108, v109
    v_cvt_pk_bf16_f32 v127, v110, v111
    ds_write_b64 v24, v[126:127] offset:416
    v_cvt_pk_bf16_f32 v120, v112, v113
    v_cvt_pk_bf16_f32 v121, v114, v115
    ds_write_b64 v24, v[120:121] offset:448
    s_nop 1
    v_cvt_pk_bf16_f32 v126, v116, v117
    v_cvt_pk_bf16_f32 v127, v118, v119
    ds_write_b64 v24, v[126:127] offset:480
    v_mov_b32 v30, 66828
    v_mov_b32 v31, 1
    s_waitcnt lgkmcnt(0)
    s_mov_b64 exec, 1
    ds_add_u32 v30, v31
    s_mov_b64 exec, -1
    v_bfe_u32 v25, v2, 2, 2
    v_and_b32 v26, 3, v2
    v_bfe_u32 v27, v2, 4, 1
    v_lshl_add_u32 v25, v33, 2, v25
    v_lshlrev_b32 v25, 6, v25
    v_lshl_add_u32 v25, v27, 5, v25
    v_lshl_add_u32 v25, v26, 3, v25
    s_mul_i32 s29, s22, 4112
    s_add_u32 s29, s29, 34048
    v_add_u32 v25, s29, v25
    s_add_u32 s30, s25, s22
    s_lshl_b32 s30, s30, 6
    s_cmp_eq_u32 s27, 1
    s_cselect_b32 s31, 32, s20
    s_add_u32 s30, s30, s31
    s_sub_u32 s31, 2048, s30
    s_cmp_eq_u32 s30, 0
    s_cselect_b32 s31, 1024, s31
    s_cselect_b32 s29, 1, 0
    v_lshlrev_b32 v28, 6, v32
    v_lshl_add_u32 v28, v33, 4, v28
    v_add_u32 v28, 2048, v28
    s_lshl_b32 s30, s30, 12
    s_lshl_b32 s31, s31, 12
    v_add_u32 v29, s30, v28
    v_add_u32 v38, s31, v28
    v_mov_b32 v30, 66828
    s_mov_b32 s13, 0
spin22:
    ds_read_b32 v31, v30
    s_waitcnt lgkmcnt(0)
    v_readfirstlane_b32 s12, v31
    s_add_u32 s13, s13, 1
    s_cmp_gt_u32 s13, 0x1000000
    s_cbranch_scc1 spin22_ok
    s_nop 0
    s_cmp_ge_u32 s12, 4
    s_cbranch_scc1 spin22_ok
    s_sleep 1
    s_branch spin22
spin22_ok:
    ds_read_b64_tr_b16 v[104:105], v25 offset:0
    ds_read_b64_tr_b16 v[106:107], v25 offset:512
    ds_read_b64_tr_b16 v[108:109], v25 offset:1024
    ds_read_b64_tr_b16 v[110:111], v25 offset:1536
    ds_read_b64_tr_b16 v[112:113], v25 offset:2056
    ds_read_b64_tr_b16 v[114:115], v25 offset:2568
    ds_read_b64_tr_b16 v[116:117], v25 offset:3080
    ds_read_b64_tr_b16 v[118:119], v25 offset:3592
    s_waitcnt lgkmcnt(0)
    v_mfma_f32_32x32x16_bf16 v[128:143], v[104:107], v[40:43], 0
    v_mfma_f32_32x32x16_bf16 v[144:159], v[104:107], v[56:59], 0
    v_mfma_f32_32x32x16_bf16 v[128:143], v[108:111], v[44:47], v[128:143]
    v_mfma_f32_32x32x16_bf16 v[144:159], v[108:111], v[60:63], v[144:159]
    v_mfma_f32_32x32x16_bf16 v[160:175], v[112:115], v[48:51], v[128:143]
    v_mfma_f32_32x32x16_bf16 v[176:191], v[112:115], v[40:43], v[144:159]
    v_mfma_f32_32x32x16_bf16 v[160:175], v[116:119], v[52:55], v[160:175]
    v_mfma_f32_32x32x16_bf16 v[176:191], v[116:119], v[44:47], v[176:191]
    s_nop 10
    v_mul_f32 v208, v160, v72
    v_mul_f32 v224, v176, v72
    v_mul_f32 v209, v161, v73
    v_mul_f32 v225, v177, v73
    v_mul_f32 v210, v162, v74
    v_mul_f32 v226, v178, v74
    v_mul_f32 v211, v163, v75
    v_mul_f32 v227, v179, v75
    v_mul_f32 v212, v164, v76
    v_mul_f32 v228, v180, v76
    v_mul_f32 v213, v165, v77
    v_mul_f32 v229, v181, v77
    v_mul_f32 v214, v166, v78
    v_mul_f32 v230, v182, v78
    v_mul_f32 v215, v167, v79
    v_mul_f32 v231, v183, v79
    v_mul_f32 v216, v168, v80
    v_mul_f32 v232, v184, v80
    v_mul_f32 v217, v169, v81
    v_mul_f32 v233, v185, v81
    v_mul_f32 v218, v170, v82
    v_mul_f32 v234, v186, v82
    v_mul_f32 v219, v171, v83
    v_mul_f32 v235, v187, v83
    v_mul_f32 v220, v172, v84
    v_mul_f32 v236, v188, v84
    v_mul_f32 v221, v173, v85
    v_mul_f32 v237, v189, v85
    v_mul_f32 v222, v174, v86
    v_mul_f32 v238, v190, v86
    v_mul_f32 v223, v175, v87
    v_mul_f32 v239, v191, v87
    v_fmac_f32 v208, v176, v88
    v_fma_f32 v224, -v160, v88, v224
    v_fmac_f32 v209, v177, v89
    v_fma_f32 v225, -v161, v89, v225
    v_fmac_f32 v210, v178, v90
    v_fma_f32 v226, -v162, v90, v226
    v_fmac_f32 v211, v179, v91
    v_fma_f32 v227, -v163, v91, v227
    v_fmac_f32 v212, v180, v92
    v_fma_f32 v228, -v164, v92, v228
    v_fmac_f32 v213, v181, v93
    v_fma_f32 v229, -v165, v93, v229
    v_fmac_f32 v214, v182, v94
    v_fma_f32 v230, -v166, v94, v230
    v_fmac_f32 v215, v183, v95
    v_fma_f32 v231, -v167, v95, v231
    v_fmac_f32 v216, v184, v96
    v_fma_f32 v232, -v168, v96, v232
    v_fmac_f32 v217, v185, v97
    v_fma_f32 v233, -v169, v97, v233
    v_fmac_f32 v218, v186, v98
    v_fma_f32 v234, -v170, v98, v234
    v_fmac_f32 v219, v187, v99
    v_fma_f32 v235, -v171, v99, v235
    v_fmac_f32 v220, v188, v100
    v_fma_f32 v236, -v172, v100, v236
    v_fmac_f32 v221, v189, v101
    v_fma_f32 v237, -v173, v101, v237
    v_fmac_f32 v222, v190, v102
    v_fma_f32 v238, -v174, v102, v238
    v_fmac_f32 v223, v191, v103
    v_fma_f32 v239, -v175, v103, v239
    v_cvt_pk_bf16_f32 v192, v208, v209
    v_cvt_pk_bf16_f32 v200, v224, v225
    v_cvt_pk_bf16_f32 v193, v210, v211
    v_cvt_pk_bf16_f32 v201, v226, v227
    v_cvt_pk_bf16_f32 v194, v212, v213
    v_cvt_pk_bf16_f32 v202, v228, v229
    v_cvt_pk_bf16_f32 v195, v214, v215
    v_cvt_pk_bf16_f32 v203, v230, v231
    v_cvt_pk_bf16_f32 v196, v216, v217
    v_cvt_pk_bf16_f32 v204, v232, v233
    v_cvt_pk_bf16_f32 v197, v218, v219
    v_cvt_pk_bf16_f32 v205, v234, v235
    v_cvt_pk_bf16_f32 v198, v220, v221
    v_cvt_pk_bf16_f32 v206, v236, v237
    v_cvt_pk_bf16_f32 v199, v222, v223
    v_cvt_pk_bf16_f32 v207, v238, v239
    v_mfma_f32_32x32x16_bf16 v[208:223], v[192:195], v[40:43], 0
    v_mfma_f32_32x32x16_bf16 v[208:223], v[196:199], v[44:47], v[208:223]
    v_mfma_f32_32x32x16_bf16 v[208:223], v[200:203], v[48:51], v[208:223]
    v_mfma_f32_32x32x16_bf16 v[208:223], v[204:207], v[52:55], v[208:223]
    s_nop 11
    v_cvt_pk_bf16_f32 v224, v208, v209
    v_cvt_pk_bf16_f32 v225, v210, v211
    v_cvt_pk_bf16_f32 v226, v212, v213
    v_cvt_pk_bf16_f32 v227, v214, v215
    v_cvt_pk_bf16_f32 v228, v216, v217
    v_cvt_pk_bf16_f32 v229, v218, v219
    v_cvt_pk_bf16_f32 v230, v220, v221
    v_cvt_pk_bf16_f32 v231, v222, v223
    v_permlane32_swap_b32 v224, v226
    v_permlane32_swap_b32 v225, v227
    v_permlane32_swap_b32 v228, v230
    v_permlane32_swap_b32 v229, v231
    buffer_store_dwordx4 v[224:227], v29, s[32:35], 0 offen
    buffer_store_dwordx4 v[228:231], v29, s[32:35], 0 offen offset:32
    s_cmp_eq_u32 s29, 1
    s_cbranch_scc0 b2_norm
    v_add_u32 v25, 16448, v25
    ds_read_b64_tr_b16 v[104:105], v25 offset:0
    ds_read_b64_tr_b16 v[106:107], v25 offset:512
    ds_read_b64_tr_b16 v[108:109], v25 offset:1024
    ds_read_b64_tr_b16 v[110:111], v25 offset:1536
    ds_read_b64_tr_b16 v[112:113], v25 offset:2056
    ds_read_b64_tr_b16 v[114:115], v25 offset:2568
    ds_read_b64_tr_b16 v[116:117], v25 offset:3080
    ds_read_b64_tr_b16 v[118:119], v25 offset:3592
    s_waitcnt lgkmcnt(0)
    v_mfma_f32_32x32x16_bf16 v[128:143], v[104:107], v[40:43], 0
    v_mfma_f32_32x32x16_bf16 v[144:159], v[104:107], v[56:59], 0
    v_mfma_f32_32x32x16_bf16 v[128:143], v[108:111], v[44:47], v[128:143]
    v_mfma_f32_32x32x16_bf16 v[144:159], v[108:111], v[60:63], v[144:159]
    s_nop 7
    s_nop 7
b2_norm:
    v_mfma_f32_32x32x16_bf16 v[160:175], v[112:115], v[56:59], v[128:143]
    v_mfma_f32_32x32x16_bf16 v[176:191], v[112:115], v[64:67], v[144:159]
    v_mfma_f32_32x32x16_bf16 v[160:175], v[116:119], v[60:63], v[160:175]
    v_mfma_f32_32x32x16_bf16 v[176:191], v[116:119], v[68:71], v[176:191]
    s_nop 10
    v_mul_f32 v208, v160, v72
    v_mul_f32 v224, v176, v72
    v_mul_f32 v209, v161, v73
    v_mul_f32 v225, v177, v73
    v_mul_f32 v210, v162, v74
    v_mul_f32 v226, v178, v74
    v_mul_f32 v211, v163, v75
    v_mul_f32 v227, v179, v75
    v_mul_f32 v212, v164, v76
    v_mul_f32 v228, v180, v76
    v_mul_f32 v213, v165, v77
    v_mul_f32 v229, v181, v77
    v_mul_f32 v214, v166, v78
    v_mul_f32 v230, v182, v78
    v_mul_f32 v215, v167, v79
    v_mul_f32 v231, v183, v79
    v_mul_f32 v216, v168, v80
    v_mul_f32 v232, v184, v80
    v_mul_f32 v217, v169, v81
    v_mul_f32 v233, v185, v81
    v_mul_f32 v218, v170, v82
    v_mul_f32 v234, v186, v82
    v_mul_f32 v219, v171, v83
    v_mul_f32 v235, v187, v83
    v_mul_f32 v220, v172, v84
    v_mul_f32 v236, v188, v84
    v_mul_f32 v221, v173, v85
    v_mul_f32 v237, v189, v85
    v_mul_f32 v222, v174, v86
    v_mul_f32 v238, v190, v86
    v_mul_f32 v223, v175, v87
    v_mul_f32 v239, v191, v87
    v_fmac_f32 v208, v176, v88
    v_fma_f32 v224, -v160, v88, v224
    v_fmac_f32 v209, v177, v89
    v_fma_f32 v225, -v161, v89, v225
    v_fmac_f32 v210, v178, v90
    v_fma_f32 v226, -v162, v90, v226
    v_fmac_f32 v211, v179, v91
    v_fma_f32 v227, -v163, v91, v227
    v_fmac_f32 v212, v180, v92
    v_fma_f32 v228, -v164, v92, v228
    v_fmac_f32 v213, v181, v93
    v_fma_f32 v229, -v165, v93, v229
    v_fmac_f32 v214, v182, v94
    v_fma_f32 v230, -v166, v94, v230
    v_fmac_f32 v215, v183, v95
    v_fma_f32 v231, -v167, v95, v231
    v_fmac_f32 v216, v184, v96
    v_fma_f32 v232, -v168, v96, v232
    v_fmac_f32 v217, v185, v97
    v_fma_f32 v233, -v169, v97, v233
    v_fmac_f32 v218, v186, v98
    v_fma_f32 v234, -v170, v98, v234
    v_fmac_f32 v219, v187, v99
    v_fma_f32 v235, -v171, v99, v235
    v_fmac_f32 v220, v188, v100
    v_fma_f32 v236, -v172, v100, v236
    v_fmac_f32 v221, v189, v101
    v_fma_f32 v237, -v173, v101, v237
    v_fmac_f32 v222, v190, v102
    v_fma_f32 v238, -v174, v102, v238
    v_fmac_f32 v223, v191, v103
    v_fma_f32 v239, -v175, v103, v239
    v_cvt_pk_bf16_f32 v192, v208, v209
    v_cvt_pk_bf16_f32 v200, v224, v225
    v_cvt_pk_bf16_f32 v193, v210, v211
    v_cvt_pk_bf16_f32 v201, v226, v227
    v_cvt_pk_bf16_f32 v194, v212, v213
    v_cvt_pk_bf16_f32 v202, v228, v229
    v_cvt_pk_bf16_f32 v195, v214, v215
    v_cvt_pk_bf16_f32 v203, v230, v231
    v_cvt_pk_bf16_f32 v196, v216, v217
    v_cvt_pk_bf16_f32 v204, v232, v233
    v_cvt_pk_bf16_f32 v197, v218, v219
    v_cvt_pk_bf16_f32 v205, v234, v235
    v_cvt_pk_bf16_f32 v198, v220, v221
    v_cvt_pk_bf16_f32 v206, v236, v237
    v_cvt_pk_bf16_f32 v199, v222, v223
    v_cvt_pk_bf16_f32 v207, v238, v239
    v_mfma_f32_32x32x16_bf16 v[208:223], v[192:195], v[40:43], 0
    v_mfma_f32_32x32x16_bf16 v[208:223], v[196:199], v[44:47], v[208:223]
    v_mfma_f32_32x32x16_bf16 v[208:223], v[200:203], v[48:51], v[208:223]
    v_mfma_f32_32x32x16_bf16 v[208:223], v[204:207], v[52:55], v[208:223]
    s_nop 11
    v_cvt_pk_bf16_f32 v224, v208, v209
    v_cvt_pk_bf16_f32 v225, v210, v211
    v_cvt_pk_bf16_f32 v226, v212, v213
    v_cvt_pk_bf16_f32 v227, v214, v215
    v_cvt_pk_bf16_f32 v228, v216, v217
    v_cvt_pk_bf16_f32 v229, v218, v219
    v_cvt_pk_bf16_f32 v230, v220, v221
    v_cvt_pk_bf16_f32 v231, v222, v223
    v_permlane32_swap_b32 v224, v226
    v_permlane32_swap_b32 v225, v227
    v_permlane32_swap_b32 v228, v230
    v_permlane32_swap_b32 v229, v231
    buffer_store_dwordx4 v[224:227], v38, s[32:35], 0 offen
    buffer_store_dwordx4 v[228:231], v38, s[32:35], 0 offen offset:32
    s_endpgm
role_a_main:
    s_mov_b32 s20, s60
    s_mov_b32 s21, s61
    s_mov_b32 s22, 4194304
    s_mov_b32 s23, 0x20000
    s_lshl_b32 s38, s75, 2
    s_add_u32 s38, s38, s37
    s_add_u32 s38, s38, s3
    s_mul_i32 s39, s3, 8512
    s_lshl_b32 s40, s38, 12
    v_and_b32 v140, 63, v0
    v_lshlrev_b32 v141, 4, v140
    s_add_u32 m0, s39, 4384
    s_nop 0
    buffer_load_dwordx4 v141, s[20:23], s40 offen offset:0 lds
    buffer_load_dwordx4 v141, s[20:23], s40 offen offset:1024 lds
    buffer_load_dwordx4 v141, s[20:23], s40 offen offset:2048 lds
    buffer_load_dwordx4 v141, s[20:23], s40 offen offset:3072 lds
    s_mov_b32 s16, s72
    s_mov_b32 s17, s73
    s_mov_b32 s18, 4194304
    s_mov_b32 s19, 0x20000
    s_add_u32 s44, s72, 12582912
    s_addc_u32 s45, s73, 0
    s_mov_b32 s46, 65536
    s_mov_b32 s47, 0x20000
    s_lshl_b32 s41, s38, 1
    s_and_b32 s41, s41, 0xfffffffc
    s_load_dword s42, s[62:63], s41
    s_load_dword s43, s[60:61], s40
    v_mov_b32 v144, 0
    v_mov_b32 v145, 0
    v_mov_b32 v146, 0
    v_mov_b32 v147, 0
    v_min_u32 v148, 5, v140
    v_lshl_add_u32 v148, v148, 4, s39
    ds_write_b128 v148, v[144:147]
    v_min_u32 v148, 9, v140
    v_lshl_add_u32 v148, v148, 4, s39
    ds_write_b128 v148, v[144:147] offset:4224
    s_mov_b32 s76, 0xffff0000
    s_barrier
    s_waitcnt vmcnt(24)
    v_lshlrev_b32 v88, 16, v20
    v_and_b32 v89, s76, v20
    v_lshlrev_b32 v90, 16, v21
    v_and_b32 v91, s76, v21
    s_waitcnt vmcnt(23)
    v_lshlrev_b32 v92, 16, v22
    v_and_b32 v93, s76, v22
    v_lshlrev_b32 v94, 16, v23
    v_and_b32 v95, s76, v23
    s_waitcnt vmcnt(22)
    v_lshlrev_b32 v96, 16, v24
    v_and_b32 v97, s76, v24
    v_lshlrev_b32 v98, 16, v25
    v_and_b32 v99, s76, v25
    s_waitcnt vmcnt(21)
    v_lshlrev_b32 v100, 16, v26
    v_and_b32 v101, s76, v26
    v_lshlrev_b32 v102, 16, v27
    v_and_b32 v103, s76, v27
    s_waitcnt vmcnt(20)
    v_lshlrev_b32 v104, 16, v28
    v_and_b32 v105, s76, v28
    v_lshlrev_b32 v106, 16, v29
    v_and_b32 v107, s76, v29
    s_waitcnt vmcnt(19)
    v_lshlrev_b32 v108, 16, v30
    v_and_b32 v109, s76, v30
    v_lshlrev_b32 v110, 16, v31
    v_and_b32 v111, s76, v31
    s_waitcnt vmcnt(18)
    v_lshlrev_b32 v112, 16, v32
    v_and_b32 v113, s76, v32
    v_lshlrev_b32 v114, 16, v33
    v_and_b32 v115, s76, v33
    s_waitcnt vmcnt(17)
    v_lshlrev_b32 v116, 16, v34
    v_and_b32 v117, s76, v34
    v_lshlrev_b32 v118, 16, v35
    v_and_b32 v119, s76, v35
    s_waitcnt vmcnt(16)
    v_lshlrev_b32 v120, 16, v36
    v_and_b32 v121, s76, v36
    v_lshlrev_b32 v122, 16, v37
    v_and_b32 v123, s76, v37
    s_waitcnt vmcnt(15)
    v_lshlrev_b32 v124, 16, v38
    v_and_b32 v125, s76, v38
    v_lshlrev_b32 v126, 16, v39
    v_and_b32 v127, s76, v39
    s_waitcnt vmcnt(14)
    v_lshlrev_b32 v128, 16, v40
    v_and_b32 v129, s76, v40
    v_lshlrev_b32 v130, 16, v41
    v_and_b32 v131, s76, v41
    s_waitcnt vmcnt(4)
    v_lshlrev_b32 v70, 16, v60
    v_and_b32 v74, s76, v60
    v_lshlrev_b32 v78, 16, v61
    v_and_b32 v82, s76, v61
    v_lshlrev_b32 v71, 16, v62
    v_and_b32 v75, s76, v62
    v_lshlrev_b32 v79, 16, v63
    v_and_b32 v83, s76, v63
    v_lshlrev_b32 v72, 16, v64
    v_and_b32 v76, s76, v64
    v_lshlrev_b32 v80, 16, v65
    v_and_b32 v84, s76, v65
    v_lshlrev_b32 v73, 16, v66
    v_and_b32 v77, s76, v66
    v_lshlrev_b32 v81, 16, v67
    v_and_b32 v85, s76, v67
    v_lshlrev_b32 v13, 12, v4
    v_lshl_add_u32 v13, v3, 1, v13
    s_mov_b32 s77, 4096
    s_mov_b32 s78, 8192
    s_mov_b32 s79, 12288
    v_lshlrev_b32 v132, 16, v42
    v_and_b32 v133, s76, v42
    v_lshlrev_b32 v134, 16, v43
    v_and_b32 v135, s76, v43
    v_pk_mul_f32 v[88:89], v[88:89], v[82:83]
    v_pk_fma_f32 v[88:89], v[92:93], v[78:79], v[88:89]
    v_pk_fma_f32 v[88:89], v[96:97], v[74:75], v[88:89]
    v_pk_fma_f32 v[88:89], v[100:101], v[70:71], v[88:89]
    v_pk_mul_f32 v[88:89], v[88:89], v[132:133]
    v_pk_mul_f32 v[90:91], v[90:91], v[84:85]
    v_pk_fma_f32 v[90:91], v[94:95], v[80:81], v[90:91]
    v_pk_fma_f32 v[90:91], v[98:99], v[76:77], v[90:91]
    v_pk_fma_f32 v[90:91], v[102:103], v[72:73], v[90:91]
    v_pk_mul_f32 v[90:91], v[90:91], v[134:135]
    v_lshlrev_b32 v136, 16, v44
    v_and_b32 v137, s76, v44
    v_lshlrev_b32 v138, 16, v45
    v_and_b32 v139, s76, v45
    v_pk_mul_f32 v[92:93], v[92:93], v[82:83]
    v_pk_fma_f32 v[92:93], v[96:97], v[78:79], v[92:93]
    v_pk_fma_f32 v[92:93], v[100:101], v[74:75], v[92:93]
    v_pk_fma_f32 v[92:93], v[104:105], v[70:71], v[92:93]
    v_pk_mul_f32 v[92:93], v[92:93], v[136:137]
    v_pk_mul_f32 v[94:95], v[94:95], v[84:85]
    v_pk_fma_f32 v[94:95], v[98:99], v[80:81], v[94:95]
    v_pk_fma_f32 v[94:95], v[102:103], v[76:77], v[94:95]
    v_pk_fma_f32 v[94:95], v[106:107], v[72:73], v[94:95]
    v_pk_mul_f32 v[94:95], v[94:95], v[138:139]
    v_lshlrev_b32 v132, 16, v46
    v_and_b32 v133, s76, v46
    v_lshlrev_b32 v134, 16, v47
    v_and_b32 v135, s76, v47
    v_pk_mul_f32 v[96:97], v[96:97], v[82:83]
    v_pk_fma_f32 v[96:97], v[100:101], v[78:79], v[96:97]
    v_pk_fma_f32 v[96:97], v[104:105], v[74:75], v[96:97]
    v_pk_fma_f32 v[96:97], v[108:109], v[70:71], v[96:97]
    v_pk_mul_f32 v[96:97], v[96:97], v[132:133]
    v_pk_mul_f32 v[98:99], v[98:99], v[84:85]
    v_pk_fma_f32 v[98:99], v[102:103], v[80:81], v[98:99]
    v_pk_fma_f32 v[98:99], v[106:107], v[76:77], v[98:99]
    v_pk_fma_f32 v[98:99], v[110:111], v[72:73], v[98:99]
    v_pk_mul_f32 v[98:99], v[98:99], v[134:135]
    v_lshlrev_b32 v136, 16, v48
    v_and_b32 v137, s76, v48
    v_lshlrev_b32 v138, 16, v49
    v_and_b32 v139, s76, v49
    v_pk_mul_f32 v[100:101], v[100:101], v[82:83]
    v_pk_fma_f32 v[100:101], v[104:105], v[78:79], v[100:101]
    v_pk_fma_f32 v[100:101], v[108:109], v[74:75], v[100:101]
    v_pk_fma_f32 v[100:101], v[112:113], v[70:71], v[100:101]
    v_pk_mul_f32 v[100:101], v[100:101], v[136:137]
    v_pk_mul_f32 v[102:103], v[102:103], v[84:85]
    v_pk_fma_f32 v[102:103], v[106:107], v[80:81], v[102:103]
    v_pk_fma_f32 v[102:103], v[110:111], v[76:77], v[102:103]
    v_pk_fma_f32 v[102:103], v[114:115], v[72:73], v[102:103]
    v_pk_mul_f32 v[102:103], v[102:103], v[138:139]
    v_lshlrev_b32 v132, 16, v50
    v_and_b32 v133, s76, v50
    v_lshlrev_b32 v134, 16, v51
    v_and_b32 v135, s76, v51
    v_pk_mul_f32 v[104:105], v[104:105], v[82:83]
    v_pk_fma_f32 v[104:105], v[108:109], v[78:79], v[104:105]
    v_pk_fma_f32 v[104:105], v[112:113], v[74:75], v[104:105]
    v_pk_fma_f32 v[104:105], v[116:117], v[70:71], v[104:105]
    v_pk_mul_f32 v[104:105], v[104:105], v[132:133]
    v_pk_mul_f32 v[106:107], v[106:107], v[84:85]
    v_pk_fma_f32 v[106:107], v[110:111], v[80:81], v[106:107]
    v_pk_fma_f32 v[106:107], v[114:115], v[76:77], v[106:107]
    v_pk_fma_f32 v[106:107], v[118:119], v[72:73], v[106:107]
    v_pk_mul_f32 v[106:107], v[106:107], v[134:135]
    v_lshlrev_b32 v136, 16, v52
    v_and_b32 v137, s76, v52
    v_lshlrev_b32 v138, 16, v53
    v_and_b32 v139, s76, v53
    v_pk_mul_f32 v[108:109], v[108:109], v[82:83]
    v_pk_fma_f32 v[108:109], v[112:113], v[78:79], v[108:109]
    v_pk_fma_f32 v[108:109], v[116:117], v[74:75], v[108:109]
    v_pk_fma_f32 v[108:109], v[120:121], v[70:71], v[108:109]
    v_pk_mul_f32 v[108:109], v[108:109], v[136:137]
    v_pk_mul_f32 v[110:111], v[110:111], v[84:85]
    v_pk_fma_f32 v[110:111], v[114:115], v[80:81], v[110:111]
    v_pk_fma_f32 v[110:111], v[118:119], v[76:77], v[110:111]
    v_pk_fma_f32 v[110:111], v[122:123], v[72:73], v[110:111]
    v_pk_mul_f32 v[110:111], v[110:111], v[138:139]
    v_lshlrev_b32 v132, 16, v54
    v_and_b32 v133, s76, v54
    v_lshlrev_b32 v134, 16, v55
    v_and_b32 v135, s76, v55
    v_pk_mul_f32 v[112:113], v[112:113], v[82:83]
    v_pk_fma_f32 v[112:113], v[116:117], v[78:79], v[112:113]
    v_pk_fma_f32 v[112:113], v[120:121], v[74:75], v[112:113]
    v_pk_fma_f32 v[112:113], v[124:125], v[70:71], v[112:113]
    v_pk_mul_f32 v[112:113], v[112:113], v[132:133]
    v_pk_mul_f32 v[114:115], v[114:115], v[84:85]
    v_pk_fma_f32 v[114:115], v[118:119], v[80:81], v[114:115]
    v_pk_fma_f32 v[114:115], v[122:123], v[76:77], v[114:115]
    v_pk_fma_f32 v[114:115], v[126:127], v[72:73], v[114:115]
    v_pk_mul_f32 v[114:115], v[114:115], v[134:135]
    v_lshlrev_b32 v136, 16, v56
    v_and_b32 v137, s76, v56
    v_lshlrev_b32 v138, 16, v57
    v_and_b32 v139, s76, v57
    v_pk_mul_f32 v[116:117], v[116:117], v[82:83]
    v_pk_fma_f32 v[116:117], v[120:121], v[78:79], v[116:117]
    v_pk_fma_f32 v[116:117], v[124:125], v[74:75], v[116:117]
    v_pk_fma_f32 v[116:117], v[128:129], v[70:71], v[116:117]
    v_pk_mul_f32 v[116:117], v[116:117], v[136:137]
    v_pk_mul_f32 v[118:119], v[118:119], v[84:85]
    v_pk_fma_f32 v[118:119], v[122:123], v[80:81], v[118:119]
    v_pk_fma_f32 v[118:119], v[126:127], v[76:77], v[118:119]
    v_pk_fma_f32 v[118:119], v[130:131], v[72:73], v[118:119]
    v_pk_mul_f32 v[118:119], v[118:119], v[138:139]
    s_mov_b32 s48, s70
    s_mov_b32 s49, s71
    s_mov_b32 s50, 256
    s_mov_b32 s51, 0x20000
    v_mov_b32 v143, 0
    s_cmp_eq_u32 s3, 0
    s_cbranch_scc0 nl2
    buffer_load_dword v149, v143, s[48:51], 0 offen
nl2:
    v_cvt_pk_bf16_f32 v20, v88, v92
    v_cvt_pk_bf16_f32 v21, v96, v100
    v_cvt_pk_bf16_f32 v22, v104, v108
    v_cvt_pk_bf16_f32 v23, v112, v116
    buffer_store_dwordx4 v[20:23], v13, s[16:19], 0 offen sc1
    v_cvt_pk_bf16_f32 v24, v89, v93
    v_cvt_pk_bf16_f32 v25, v97, v101
    v_cvt_pk_bf16_f32 v26, v105, v109
    v_cvt_pk_bf16_f32 v27, v113, v117
    buffer_store_dwordx4 v[24:27], v13, s[16:19], s77 offen sc1
    v_cvt_pk_bf16_f32 v28, v90, v94
    v_cvt_pk_bf16_f32 v29, v98, v102
    v_cvt_pk_bf16_f32 v30, v106, v110
    v_cvt_pk_bf16_f32 v31, v114, v118
    buffer_store_dwordx4 v[28:31], v13, s[16:19], s78 offen sc1
    v_cvt_pk_bf16_f32 v32, v91, v95
    v_cvt_pk_bf16_f32 v33, v99, v103
    v_cvt_pk_bf16_f32 v34, v107, v111
    v_cvt_pk_bf16_f32 v35, v115, v119
    buffer_store_dwordx4 v[32:35], v13, s[16:19], s79 offen sc1
    v_lshrrev_b32 v9, 4, v140
    v_bfe_u32 v10, v140, 2, 2
    v_and_b32 v11, 3, v140
    v_lshlrev_b32 v14, 5, v11
    v_lshl_add_u32 v14, v9, 6, v14
    v_lshl_add_u32 v14, v10, 3, v14
    v_add_u32 v14, s39, v14
    v_lshlrev_b32 v15, 3, v11
    v_lshlrev_b32 v16, 6, v9
    v_sub_u32 v15, v15, v16
    v_lshlrev_b32 v16, 3, v10
    v_sub_u32 v15, v15, v16
    s_add_u32 s77, s39, 4448
    v_add_u32 v15, s77, v15
    s_and_b32 s77, s38, 1
    s_cmp_eq_u32 s77, 0
    s_cselect_b32 s77, 16, 0
    s_waitcnt lgkmcnt(0)
    s_lshl_b32 s42, s42, s77
    s_and_b32 s42, s42, 0xffff0000
    s_lshl_b32 s43, s43, 16
    v_mov_b32 v16, s42
    v_add_f32 v16, s43, v16
    v_cvt_pk_bf16_f32 v16, v16, v16
    v_mov_b32 v17, s39
    s_lshl_b32 s77, s74, 8
    v_and_b32 v142, 15, v140
    v_lshlrev_b32 v142, 2, v142
    s_lshl_b32 s79, s75, 2
    v_add_u32 v142, s77, v142
    v_add_u32 v142, 24576, v142
    s_add_u32 s79, s79, s77
    v_mov_b32 v18, s79
    v_add_u32 v19, 24576, v18
    s_waitcnt vmcnt(0)
    s_cmp_eq_u32 s3, 0
    s_cbranch_scc0 nz3_done
    s_memrealtime s[80:81]
    v_readfirstlane_b32 s79, v149
    s_waitcnt lgkmcnt(0)
    s_nop 2
    s_sub_u32 s80, s80, s79
    s_cmp_lt_u32 s80, 1000
    s_cbranch_scc1 nz3_ok
    s_mov_b32 s81, 0
nz3:
    buffer_load_dword v149, v143, s[48:51], 0 offen sc1
    s_waitcnt vmcnt(0)
    v_readfirstlane_b32 s80, v149
    s_nop 3
    s_cmp_lg_u32 s80, 0
    s_cbranch_scc1 nz3_ok
    s_add_u32 s81, s81, 1
    s_cmp_gt_u32 s81, 0x80000
    s_cbranch_scc1 nz3_ok
    s_sleep 4
    s_branch nz3
nz3_ok:
    v_mov_b32 v12, 66816
    ds_write_b32 v12, v149
nz3_done:
    v_mov_b32 v12, 66816
    s_mov_b32 s81, 0
spin4:
    ds_read_b32 v13, v12
    s_waitcnt lgkmcnt(0)
    v_readfirstlane_b32 s80, v13
    s_add_u32 s81, s81, 1
    s_cmp_gt_u32 s81, 0x1000000
    s_cbranch_scc1 spin4_ok
    s_nop 0
    s_cmp_ge_u32 s80, 1
    s_cbranch_scc1 spin4_ok
    s_sleep 1
    s_branch spin4
spin4_ok:
    v_mov_b32 v149, v13
    v_mov_b32 v12, 66820
    v_mov_b32 v13, 1
    s_mov_b64 exec, 1
    ds_add_rtn_u32 v13, v12, v13
    s_waitcnt lgkmcnt(0)
    s_mov_b64 exec, -1
    v_readfirstlane_b32 s80, v13
    s_nop 3
    s_cmp_eq_u32 s80, 3
    s_cbranch_scc0 f15
    s_mov_b64 exec, 1
    buffer_store_dword v149, v19, s[44:47], 0 offen
    buffer_store_dword v149, v18, s[44:47], 0 offen sc1
    s_mov_b64 exec, -1
f15:
    s_cmp_eq_u32 s3, 0
    s_cbranch_scc0 wp6_spin
    s_mov_b32 s80, 0
pt7:
    buffer_load_dword v12, v142, s[44:47], 0 offen nt
    s_waitcnt vmcnt(0)
    v_cmp_ne_u32 vcc, v12, v149
    s_nop 4
    s_cbranch_vccz pt7_ok
    s_add_u32 s80, s80, 1
    s_and_b32 s81, s80, 3
    s_cmp_eq_u32 s81, 0
    s_cbranch_scc1 pt7_glob
    s_sleep 1
    s_branch pt7
pt7_glob:
    s_cmp_gt_u32 s80, 0x80000
    s_cbranch_scc1 pt7_ok
    v_subrev_u32 v13, 24576, v142
    buffer_load_dword v12, v13, s[44:47], 0 offen sc1
    s_waitcnt vmcnt(0)
    v_cmp_ne_u32 vcc, v12, v149
    s_nop 4
    s_cbranch_vccnz pt7
pt7_ok:
    v_mov_b32 v12, 66836
    v_mov_b32 v13, 1
    ds_write_b32 v12, v13
    s_branch wp6_done
wp6_spin:
    v_mov_b32 v12, 66836
    s_mov_b32 s81, 0
spin8:
    ds_read_b32 v13, v12
    s_waitcnt lgkmcnt(0)
    v_readfirstlane_b32 s80, v13
    s_add_u32 s81, s81, 1
    s_cmp_gt_u32 s81, 0x1000000
    s_cbranch_scc1 spin8_ok
    s_nop 0
    s_cmp_ge_u32 s80, 1
    s_cbranch_scc1 spin8_ok
    s_sleep 1
    s_branch spin8
spin8_ok:
wp6_done:
    s_add_u32 m0, s39, 96
    s_nop 0
    buffer_load_dwordx4 v141, s[16:19], s40 offen offset:0 lds
    buffer_load_dwordx4 v141, s[16:19], s40 offen offset:1024 lds
    buffer_load_dwordx4 v141, s[16:19], s40 offen offset:2048 lds
    buffer_load_dwordx4 v141, s[16:19], s40 offen offset:3072 lds
    s_add_u32 s24, s72, 8388608
    s_addc_u32 s25, s73, 0
    s_mov_b32 s26, 4194304
    s_mov_b32 s27, 0x20000
    s_mov_b32 s28, s52
    s_mov_b32 s29, s53
    s_mov_b32 s30, 4194304
    s_mov_b32 s31, 0x20000
    s_mov_b32 s32, s68
    s_mov_b32 s33, s69
    s_mov_b32 s34, 8388608
    s_mov_b32 s35, 0x20000
    s_setprio 2
    v_mov_b32 v237, v149
    v_add_u32 v238, 4096, v142
    v_mov_b32 v239, v141
    v_mov_b32 v240, v3
    v_mov_b32 v241, v4
    v_add_u32 v242, 4096, v18
    v_mov_b32 v234, 0
    v_add_u32 v243, s39, v141
    v_and_b32 v12, 1, v140
    v_mul_u32_u24 v13, 126, v12
    v_lshl_add_u32 v236, v140, 1, s39
    v_add_u32 v236, v236, v13
    v_mov_b32 v255, 0x05040100
    v_mov_b32 v13, 0x03020706
    v_cmp_eq_u32 vcc, 1, v12
    s_nop 1
    v_cndmask_b32 v255, v255, v13, vcc
    s_waitcnt vmcnt(0)
    ds_write_b16 v17, v16 offset:4384
    ds_read_b64_tr_b16 v[84:85], v15 offset:32
    ds_read_b64_tr_b16 v[86:87], v15 offset:0
    ds_read_b64_tr_b16 v[20:21], v14 offset:0
    ds_read_b64_tr_b16 v[22:23], v14 offset:32
    ds_read_b64_tr_b16 v[24:25], v14 offset:256
    ds_read_b64_tr_b16 v[26:27], v14 offset:288
    ds_read_b64_tr_b16 v[88:89], v15 offset:160
    ds_read_b64_tr_b16 v[90:91], v15 offset:128
    ds_read_b64_tr_b16 v[28:29], v14 offset:512
    ds_read_b64_tr_b16 v[30:31], v14 offset:544
    ds_read_b64_tr_b16 v[32:33], v14 offset:768
    ds_read_b64_tr_b16 v[34:35], v14 offset:800
    ds_read_b64_tr_b16 v[36:37], v14 offset:1024
    ds_read_b64_tr_b16 v[38:39], v14 offset:1056
    ds_read_b64_tr_b16 v[40:41], v14 offset:1280
    ds_read_b64_tr_b16 v[42:43], v14 offset:1312
    s_waitcnt lgkmcnt(12)
    v_mfma_f32_16x16x32_bf16 v[100:103], v[20:23], v[84:87], 0
    ds_read_b64_tr_b16 v[44:45], v14 offset:1536
    ds_read_b64_tr_b16 v[46:47], v14 offset:1568
    s_waitcnt lgkmcnt(12)
    v_mfma_f32_16x16x32_bf16 v[108:111], v[24:27], v[84:87], 0
    ds_read_b64_tr_b16 v[48:49], v14 offset:1792
    ds_read_b64_tr_b16 v[50:51], v14 offset:1824
    s_waitcnt lgkmcnt(10)
    v_mfma_f32_16x16x32_bf16 v[116:119], v[28:31], v[84:87], 0
    v_add_f32_dpp v228, v234, v102 wave_ror:1 row_mask:0x1 bank_mask:0x1
    v_add_f32_dpp v230, v234, v101 wave_ror:1 row_mask:0x1 bank_mask:0x1
    ds_read_b64_tr_b16 v[52:53], v14 offset:2048
    ds_read_b64_tr_b16 v[54:55], v14 offset:2080
    s_waitcnt lgkmcnt(10)
    v_mfma_f32_16x16x32_bf16 v[124:127], v[32:35], v[84:87], 0
    v_add_f32_dpp v232, v234, v100 wave_ror:1 row_mask:0x1 bank_mask:0x1
    v_add_f32_dpp v228, v103, v102 wave_shr:1 row_mask:0xf bank_mask:0xf
    ds_read_b64_tr_b16 v[56:57], v14 offset:2304
    ds_read_b64_tr_b16 v[58:59], v14 offset:2336
    s_waitcnt lgkmcnt(10)
    v_mfma_f32_16x16x32_bf16 v[132:135], v[36:39], v[84:87], 0
    v_add_f32_dpp v230, v228, v101 wave_shr:1 row_mask:0xf bank_mask:0xf
    ds_read_b64_tr_b16 v[60:61], v14 offset:2560
    ds_read_b64_tr_b16 v[62:63], v14 offset:2592
    s_waitcnt lgkmcnt(10)
    v_mfma_f32_16x16x32_bf16 v[140:143], v[40:43], v[84:87], 0
    v_add_f32_dpp v232, v230, v100 wave_shr:1 row_mask:0xf bank_mask:0xf
    ds_read_b64_tr_b16 v[64:65], v14 offset:2816
    ds_read_b64_tr_b16 v[66:67], v14 offset:2848
    s_waitcnt lgkmcnt(10)
    v_mfma_f32_16x16x32_bf16 v[148:151], v[44:47], v[84:87], 0
    ds_read_b64_tr_b16 v[68:69], v14 offset:3072
    ds_read_b64_tr_b16 v[70:71], v14 offset:3104
    s_waitcnt lgkmcnt(10)
    v_mfma_f32_16x16x32_bf16 v[156:159], v[48:51], v[84:87], 0
    ds_read_b64_tr_b16 v[72:73], v14 offset:3328
    ds_read_b64_tr_b16 v[74:75], v14 offset:3360
    s_waitcnt lgkmcnt(10)
    v_mfma_f32_16x16x32_bf16 v[164:167], v[52:55], v[84:87], 0
    ds_read_b64_tr_b16 v[76:77], v14 offset:3584
    ds_read_b64_tr_b16 v[78:79], v14 offset:3616
    s_waitcnt lgkmcnt(10)
    v_mfma_f32_16x16x32_bf16 v[172:175], v[56:59], v[84:87], 0
    ds_read_b64_tr_b16 v[80:81], v14 offset:3840
    ds_read_b64_tr_b16 v[82:83], v14 offset:3872
    s_waitcnt lgkmcnt(10)
    v_mfma_f32_16x16x32_bf16 v[180:183], v[60:63], v[84:87], 0
    ds_read_b64_tr_b16 v[92:93], v15 offset:288
    ds_read_b64_tr_b16 v[94:95], v15 offset:256
    s_waitcnt lgkmcnt(10)
    v_mfma_f32_16x16x32_bf16 v[188:191], v[64:67], v[84:87], 0
    s_waitcnt lgkmcnt(8)
    v_mfma_f32_16x16x32_bf16 v[196:199], v[68:71], v[84:87], 0
    ds_read_b64_tr_b16 v[96:97], v15 offset:416
    ds_read_b64_tr_b16 v[98:99], v15 offset:384
    s_waitcnt lgkmcnt(8)
    v_mfma_f32_16x16x32_bf16 v[204:207], v[72:75], v[84:87], 0
    s_waitcnt lgkmcnt(6)
    v_mfma_f32_16x16x32_bf16 v[212:215], v[76:79], v[84:87], 0
    s_waitcnt lgkmcnt(4)
    v_mfma_f32_16x16x32_bf16 v[220:223], v[80:83], v[84:87], 0
    s_nop 0
    v_mfma_f32_16x16x32_bf16 v[104:107], v[20:23], v[88:91], 0
    ds_read_b64_tr_b16 v[84:85], v15 offset:544
    ds_read_b64_tr_b16 v[86:87], v15 offset:512
    v_mfma_f32_16x16x32_bf16 v[112:115], v[24:27], v[88:91], 0
    v_mfma_f32_16x16x32_bf16 v[120:123], v[28:31], v[88:91], 0
    v_mfma_f32_16x16x32_bf16 v[128:131], v[32:35], v[88:91], 0
    v_mfma_f32_16x16x32_bf16 v[136:139], v[36:39], v[88:91], 0
    v_mfma_f32_16x16x32_bf16 v[144:147], v[40:43], v[88:91], 0
    v_mfma_f32_16x16x32_bf16 v[152:155], v[44:47], v[88:91], 0
    v_add_f32_dpp v229, v103, v106 wave_ror:1 row_mask:0x1 bank_mask:0x1
    v_add_f32_dpp v231, v228, v105 wave_ror:1 row_mask:0x1 bank_mask:0x1
    v_mfma_f32_16x16x32_bf16 v[160:163], v[48:51], v[88:91], 0
    v_add_f32_dpp v233, v230, v104 wave_ror:1 row_mask:0x1 bank_mask:0x1
    v_add_f32_dpp v229, v107, v106 wave_shr:1 row_mask:0xf bank_mask:0xf
    v_mfma_f32_16x16x32_bf16 v[168:171], v[52:55], v[88:91], 0
    v_mfma_f32_16x16x32_bf16 v[176:179], v[56:59], v[88:91], 0
    v_add_f32_dpp v231, v229, v105 wave_shr:1 row_mask:0xf bank_mask:0xf
    v_mfma_f32_16x16x32_bf16 v[184:187], v[60:63], v[88:91], 0
    v_mfma_f32_16x16x32_bf16 v[192:195], v[64:67], v[88:91], 0
    v_add_f32_dpp v233, v231, v104 wave_shr:1 row_mask:0xf bank_mask:0xf
    v_mfma_f32_16x16x32_bf16 v[200:203], v[68:71], v[88:91], 0
    v_cvt_pk_bf16_f32 v235, v232, v233
    v_mfma_f32_16x16x32_bf16 v[208:211], v[72:75], v[88:91], 0
    v_mfma_f32_16x16x32_bf16 v[216:219], v[76:79], v[88:91], 0
    v_mov_b32_dpp v253, v235 quad_perm:[1,0,3,2] row_mask:0xf bank_mask:0xf
    v_mfma_f32_16x16x32_bf16 v[224:227], v[80:83], v[88:91], 0
    v_perm_b32 v253, v253, v235, v255
    s_waitcnt lgkmcnt(4)
    v_mfma_f32_16x16x32_bf16 v[108:111], v[20:23], v[92:95], v[108:111]
    ds_read_b64_tr_b16 v[88:89], v15 offset:672
    ds_read_b64_tr_b16 v[90:91], v15 offset:640
    v_mfma_f32_16x16x32_bf16 v[116:119], v[24:27], v[92:95], v[116:119]
    ds_read_b64_tr_b16 v[80:81], v15 offset:800
    ds_read_b64_tr_b16 v[82:83], v15 offset:768
    v_mfma_f32_16x16x32_bf16 v[124:127], v[28:31], v[92:95], v[124:127]
    ds_write_b32 v236, v253 offset:0
    v_mfma_f32_16x16x32_bf16 v[132:135], v[32:35], v[92:95], v[132:135]
    v_add_f32_dpp v248, v107, v110 wave_ror:1 row_mask:0x1 bank_mask:0x1
    v_add_f32_dpp v249, v229, v109 wave_ror:1 row_mask:0x1 bank_mask:0x1
    v_mfma_f32_16x16x32_bf16 v[140:143], v[36:39], v[92:95], v[140:143]
    v_add_f32_dpp v250, v231, v108 wave_ror:1 row_mask:0x1 bank_mask:0x1
    v_add_f32_dpp v248, v111, v110 wave_shr:1 row_mask:0xf bank_mask:0xf
    v_mfma_f32_16x16x32_bf16 v[148:151], v[40:43], v[92:95], v[148:151]
    v_mfma_f32_16x16x32_bf16 v[156:159], v[44:47], v[92:95], v[156:159]
    v_add_f32_dpp v249, v248, v109 wave_shr:1 row_mask:0xf bank_mask:0xf
    v_mfma_f32_16x16x32_bf16 v[164:167], v[48:51], v[92:95], v[164:167]
    v_mfma_f32_16x16x32_bf16 v[172:175], v[52:55], v[92:95], v[172:175]
    v_add_f32_dpp v250, v249, v108 wave_shr:1 row_mask:0xf bank_mask:0xf
    v_mfma_f32_16x16x32_bf16 v[180:183], v[56:59], v[92:95], v[180:183]
    v_mfma_f32_16x16x32_bf16 v[188:191], v[60:63], v[92:95], v[188:191]
    v_mfma_f32_16x16x32_bf16 v[196:199], v[64:67], v[92:95], v[196:199]
    v_mfma_f32_16x16x32_bf16 v[204:207], v[68:71], v[92:95], v[204:207]
    v_mfma_f32_16x16x32_bf16 v[212:215], v[72:75], v[92:95], v[212:215]
    v_mfma_f32_16x16x32_bf16 v[220:223], v[76:79], v[92:95], v[220:223]
    s_waitcnt lgkmcnt(7)
    v_mfma_f32_16x16x32_bf16 v[112:115], v[20:23], v[96:99], v[112:115]
    ds_read_b64_tr_b16 v[92:93], v15 offset:928
    ds_read_b64_tr_b16 v[94:95], v15 offset:896
    v_mfma_f32_16x16x32_bf16 v[120:123], v[24:27], v[96:99], v[120:123]
    v_mfma_f32_16x16x32_bf16 v[128:131], v[28:31], v[96:99], v[128:131]
    v_mfma_f32_16x16x32_bf16 v[136:139], v[32:35], v[96:99], v[136:139]
    v_mfma_f32_16x16x32_bf16 v[144:147], v[36:39], v[96:99], v[144:147]
    v_mfma_f32_16x16x32_bf16 v[152:155], v[40:43], v[96:99], v[152:155]
    v_mfma_f32_16x16x32_bf16 v[160:163], v[44:47], v[96:99], v[160:163]
    v_add_f32_dpp v228, v111, v114 wave_ror:1 row_mask:0x1 bank_mask:0x1
    v_add_f32_dpp v230, v248, v113 wave_ror:1 row_mask:0x1 bank_mask:0x1
    v_mfma_f32_16x16x32_bf16 v[168:171], v[48:51], v[96:99], v[168:171]
    v_add_f32_dpp v251, v249, v112 wave_ror:1 row_mask:0x1 bank_mask:0x1
    v_add_f32_dpp v228, v115, v114 wave_shr:1 row_mask:0xf bank_mask:0xf
    v_mfma_f32_16x16x32_bf16 v[176:179], v[52:55], v[96:99], v[176:179]
    v_mfma_f32_16x16x32_bf16 v[184:187], v[56:59], v[96:99], v[184:187]
    v_add_f32_dpp v230, v228, v113 wave_shr:1 row_mask:0xf bank_mask:0xf
    v_mfma_f32_16x16x32_bf16 v[192:195], v[60:63], v[96:99], v[192:195]
    v_mfma_f32_16x16x32_bf16 v[200:203], v[64:67], v[96:99], v[200:203]
    v_add_f32_dpp v251, v230, v112 wave_shr:1 row_mask:0xf bank_mask:0xf
    v_mfma_f32_16x16x32_bf16 v[208:211], v[68:71], v[96:99], v[208:211]
    v_cvt_pk_bf16_f32 v252, v250, v251
    v_mfma_f32_16x16x32_bf16 v[216:219], v[72:75], v[96:99], v[216:219]
    v_mfma_f32_16x16x32_bf16 v[224:227], v[76:79], v[96:99], v[224:227]
    v_mov_b32_dpp v254, v252 quad_perm:[1,0,3,2] row_mask:0xf bank_mask:0xf
    s_waitcnt lgkmcnt(7)
    v_mfma_f32_16x16x32_bf16 v[116:119], v[20:23], v[84:87], v[116:119]
    ds_read_b64_tr_b16 v[96:97], v15 offset:1056
    ds_read_b64_tr_b16 v[98:99], v15 offset:1024
    v_mfma_f32_16x16x32_bf16 v[124:127], v[24:27], v[84:87], v[124:127]
    ds_read_b64_tr_b16 v[76:77], v15 offset:1184
    ds_read_b64_tr_b16 v[78:79], v15 offset:1152
    v_mfma_f32_16x16x32_bf16 v[132:135], v[28:31], v[84:87], v[132:135]
    v_perm_b32 v254, v254, v252, v255
    v_mfma_f32_16x16x32_bf16 v[140:143], v[32:35], v[84:87], v[140:143]
    v_add_f32_dpp v229, v115, v118 wave_ror:1 row_mask:0x1 bank_mask:0x1
    v_add_f32_dpp v231, v228, v117 wave_ror:1 row_mask:0x1 bank_mask:0x1
    v_mfma_f32_16x16x32_bf16 v[148:151], v[36:39], v[84:87], v[148:151]
    ds_write_b32 v236, v254 offset:256
    v_mfma_f32_16x16x32_bf16 v[156:159], v[40:43], v[84:87], v[156:159]
    v_add_f32_dpp v232, v230, v116 wave_ror:1 row_mask:0x1 bank_mask:0x1
    v_add_f32_dpp v229, v119, v118 wave_shr:1 row_mask:0xf bank_mask:0xf
    v_mfma_f32_16x16x32_bf16 v[164:167], v[44:47], v[84:87], v[164:167]
    v_mfma_f32_16x16x32_bf16 v[172:175], v[48:51], v[84:87], v[172:175]
    v_add_f32_dpp v231, v229, v117 wave_shr:1 row_mask:0xf bank_mask:0xf
    v_mfma_f32_16x16x32_bf16 v[180:183], v[52:55], v[84:87], v[180:183]
    v_mfma_f32_16x16x32_bf16 v[188:191], v[56:59], v[84:87], v[188:191]
    v_add_f32_dpp v232, v231, v116 wave_shr:1 row_mask:0xf bank_mask:0xf
    v_mfma_f32_16x16x32_bf16 v[196:199], v[60:63], v[84:87], v[196:199]
    v_mfma_f32_16x16x32_bf16 v[204:207], v[64:67], v[84:87], v[204:207]
    v_mfma_f32_16x16x32_bf16 v[212:215], v[68:71], v[84:87], v[212:215]
    v_mfma_f32_16x16x32_bf16 v[220:223], v[72:75], v[84:87], v[220:223]
    s_waitcnt lgkmcnt(10)
    v_mfma_f32_16x16x32_bf16 v[120:123], v[20:23], v[88:91], v[120:123]
    ds_read_b64_tr_b16 v[84:85], v15 offset:1312
    ds_read_b64_tr_b16 v[86:87], v15 offset:1280
    v_mfma_f32_16x16x32_bf16 v[128:131], v[24:27], v[88:91], v[128:131]
    v_mfma_f32_16x16x32_bf16 v[136:139], v[28:31], v[88:91], v[136:139]
    v_mfma_f32_16x16x32_bf16 v[144:147], v[32:35], v[88:91], v[144:147]
    v_mfma_f32_16x16x32_bf16 v[152:155], v[36:39], v[88:91], v[152:155]
    v_mfma_f32_16x16x32_bf16 v[160:163], v[40:43], v[88:91], v[160:163]
    v_mfma_f32_16x16x32_bf16 v[168:171], v[44:47], v[88:91], v[168:171]
    v_add_f32_dpp v248, v119, v122 wave_ror:1 row_mask:0x1 bank_mask:0x1
    v_add_f32_dpp v249, v229, v121 wave_ror:1 row_mask:0x1 bank_mask:0x1
    v_mfma_f32_16x16x32_bf16 v[176:179], v[48:51], v[88:91], v[176:179]
    v_add_f32_dpp v233, v231, v120 wave_ror:1 row_mask:0x1 bank_mask:0x1
    v_add_f32_dpp v248, v123, v122 wave_shr:1 row_mask:0xf bank_mask:0xf
    v_mfma_f32_16x16x32_bf16 v[184:187], v[52:55], v[88:91], v[184:187]
    v_mfma_f32_16x16x32_bf16 v[192:195], v[56:59], v[88:91], v[192:195]
    v_add_f32_dpp v249, v248, v121 wave_shr:1 row_mask:0xf bank_mask:0xf
    v_mfma_f32_16x16x32_bf16 v[200:203], v[60:63], v[88:91], v[200:203]
    v_mfma_f32_16x16x32_bf16 v[208:211], v[64:67], v[88:91], v[208:211]
    v_add_f32_dpp v233, v249, v120 wave_shr:1 row_mask:0xf bank_mask:0xf
    v_mfma_f32_16x16x32_bf16 v[216:219], v[68:71], v[88:91], v[216:219]
    v_cvt_pk_bf16_f32 v235, v232, v233
    v_mfma_f32_16x16x32_bf16 v[224:227], v[72:75], v[88:91], v[224:227]
    s_waitcnt lgkmcnt(10)
    v_mfma_f32_16x16x32_bf16 v[124:127], v[20:23], v[80:83], v[124:127]
    ds_read_b64_tr_b16 v[88:89], v15 offset:1440
    ds_read_b64_tr_b16 v[90:91], v15 offset:1408
    v_mfma_f32_16x16x32_bf16 v[132:135], v[24:27], v[80:83], v[132:135]
    ds_read_b64_tr_b16 v[72:73], v15 offset:1568
    ds_read_b64_tr_b16 v[74:75], v15 offset:1536
    v_mfma_f32_16x16x32_bf16 v[140:143], v[28:31], v[80:83], v[140:143]
    v_mov_b32_dpp v253, v235 quad_perm:[1,0,3,2] row_mask:0xf bank_mask:0xf
    v_mfma_f32_16x16x32_bf16 v[148:151], v[32:35], v[80:83], v[148:151]
    v_perm_b32 v253, v253, v235, v255
    v_add_f32_dpp v228, v123, v126 wave_ror:1 row_mask:0x1 bank_mask:0x1
    v_mfma_f32_16x16x32_bf16 v[156:159], v[36:39], v[80:83], v[156:159]
    v_add_f32_dpp v230, v248, v125 wave_ror:1 row_mask:0x1 bank_mask:0x1
    v_add_f32_dpp v250, v249, v124 wave_ror:1 row_mask:0x1 bank_mask:0x1
    v_mfma_f32_16x16x32_bf16 v[164:167], v[40:43], v[80:83], v[164:167]
    ds_write_b32 v236, v253 offset:512
    v_mfma_f32_16x16x32_bf16 v[172:175], v[44:47], v[80:83], v[172:175]
    v_add_f32_dpp v228, v127, v126 wave_shr:1 row_mask:0xf bank_mask:0xf
    v_mfma_f32_16x16x32_bf16 v[180:183], v[48:51], v[80:83], v[180:183]
    v_mfma_f32_16x16x32_bf16 v[188:191], v[52:55], v[80:83], v[188:191]
    v_add_f32_dpp v230, v228, v125 wave_shr:1 row_mask:0xf bank_mask:0xf
    v_mfma_f32_16x16x32_bf16 v[196:199], v[56:59], v[80:83], v[196:199]
    v_mfma_f32_16x16x32_bf16 v[204:207], v[60:63], v[80:83], v[204:207]
    v_add_f32_dpp v250, v230, v124 wave_shr:1 row_mask:0xf bank_mask:0xf
    v_mfma_f32_16x16x32_bf16 v[212:215], v[64:67], v[80:83], v[212:215]
    v_mfma_f32_16x16x32_bf16 v[220:223], v[68:71], v[80:83], v[220:223]
    s_waitcnt lgkmcnt(12)
    v_mfma_f32_16x16x32_bf16 v[128:131], v[20:23], v[92:95], v[128:131]
    ds_read_b64_tr_b16 v[80:81], v15 offset:1696
    ds_read_b64_tr_b16 v[82:83], v15 offset:1664
    v_mfma_f32_16x16x32_bf16 v[136:139], v[24:27], v[92:95], v[136:139]
    v_mfma_f32_16x16x32_bf16 v[144:147], v[28:31], v[92:95], v[144:147]
    v_mfma_f32_16x16x32_bf16 v[152:155], v[32:35], v[92:95], v[152:155]
    v_mfma_f32_16x16x32_bf16 v[160:163], v[36:39], v[92:95], v[160:163]
    v_mfma_f32_16x16x32_bf16 v[168:171], v[40:43], v[92:95], v[168:171]
    v_mfma_f32_16x16x32_bf16 v[176:179], v[44:47], v[92:95], v[176:179]
    v_add_f32_dpp v229, v127, v130 wave_ror:1 row_mask:0x1 bank_mask:0x1
    v_add_f32_dpp v231, v228, v129 wave_ror:1 row_mask:0x1 bank_mask:0x1
    v_mfma_f32_16x16x32_bf16 v[184:187], v[48:51], v[92:95], v[184:187]
    v_add_f32_dpp v251, v230, v128 wave_ror:1 row_mask:0x1 bank_mask:0x1
    v_add_f32_dpp v229, v131, v130 wave_shr:1 row_mask:0xf bank_mask:0xf
    v_mfma_f32_16x16x32_bf16 v[192:195], v[52:55], v[92:95], v[192:195]
    v_mfma_f32_16x16x32_bf16 v[200:203], v[56:59], v[92:95], v[200:203]
    v_add_f32_dpp v231, v229, v129 wave_shr:1 row_mask:0xf bank_mask:0xf
    v_mfma_f32_16x16x32_bf16 v[208:211], v[60:63], v[92:95], v[208:211]
    v_mfma_f32_16x16x32_bf16 v[216:219], v[64:67], v[92:95], v[216:219]
    v_add_f32_dpp v251, v231, v128 wave_shr:1 row_mask:0xf bank_mask:0xf
    v_mfma_f32_16x16x32_bf16 v[224:227], v[68:71], v[92:95], v[224:227]
    v_cvt_pk_bf16_f32 v252, v250, v251
    s_waitcnt lgkmcnt(12)
    v_mfma_f32_16x16x32_bf16 v[132:135], v[20:23], v[96:99], v[132:135]
    ds_read_b64_tr_b16 v[92:93], v15 offset:1824
    ds_read_b64_tr_b16 v[94:95], v15 offset:1792
    v_mfma_f32_16x16x32_bf16 v[140:143], v[24:27], v[96:99], v[140:143]
    ds_read_b64_tr_b16 v[68:69], v15 offset:1952
    ds_read_b64_tr_b16 v[70:71], v15 offset:1920
    v_mfma_f32_16x16x32_bf16 v[148:151], v[28:31], v[96:99], v[148:151]
    v_mov_b32_dpp v254, v252 quad_perm:[1,0,3,2] row_mask:0xf bank_mask:0xf
    v_mfma_f32_16x16x32_bf16 v[156:159], v[32:35], v[96:99], v[156:159]
    v_perm_b32 v254, v254, v252, v255
    v_add_f32_dpp v248, v131, v134 wave_ror:1 row_mask:0x1 bank_mask:0x1
    v_mfma_f32_16x16x32_bf16 v[164:167], v[36:39], v[96:99], v[164:167]
    v_add_f32_dpp v249, v229, v133 wave_ror:1 row_mask:0x1 bank_mask:0x1
    v_add_f32_dpp v232, v231, v132 wave_ror:1 row_mask:0x1 bank_mask:0x1
    v_mfma_f32_16x16x32_bf16 v[172:175], v[40:43], v[96:99], v[172:175]
    ds_write_b32 v236, v254 offset:768
    v_mfma_f32_16x16x32_bf16 v[180:183], v[44:47], v[96:99], v[180:183]
    ds_read_b128 v[244:247], v243 offset:0
    v_add_f32_dpp v248, v135, v134 wave_shr:1 row_mask:0xf bank_mask:0xf
    v_mfma_f32_16x16x32_bf16 v[188:191], v[48:51], v[96:99], v[188:191]
    v_mfma_f32_16x16x32_bf16 v[196:199], v[52:55], v[96:99], v[196:199]
    v_add_f32_dpp v249, v248, v133 wave_shr:1 row_mask:0xf bank_mask:0xf
    v_mfma_f32_16x16x32_bf16 v[204:207], v[56:59], v[96:99], v[204:207]
    v_mfma_f32_16x16x32_bf16 v[212:215], v[60:63], v[96:99], v[212:215]
    v_add_f32_dpp v232, v249, v132 wave_shr:1 row_mask:0xf bank_mask:0xf
    v_mfma_f32_16x16x32_bf16 v[220:223], v[64:67], v[96:99], v[220:223]
    s_waitcnt lgkmcnt(15)
    v_mfma_f32_16x16x32_bf16 v[136:139], v[20:23], v[76:79], v[136:139]
    ds_read_b64_tr_b16 v[96:97], v15 offset:2080
    ds_read_b64_tr_b16 v[98:99], v15 offset:2048
    v_mfma_f32_16x16x32_bf16 v[144:147], v[24:27], v[76:79], v[144:147]
    v_mfma_f32_16x16x32_bf16 v[152:155], v[28:31], v[76:79], v[152:155]
    v_mfma_f32_16x16x32_bf16 v[160:163], v[32:35], v[76:79], v[160:163]
    v_mfma_f32_16x16x32_bf16 v[168:171], v[36:39], v[76:79], v[168:171]
    v_mfma_f32_16x16x32_bf16 v[176:179], v[40:43], v[76:79], v[176:179]
    v_mfma_f32_16x16x32_bf16 v[184:187], v[44:47], v[76:79], v[184:187]
    v_add_f32_dpp v228, v135, v138 wave_ror:1 row_mask:0x1 bank_mask:0x1
    v_add_f32_dpp v230, v248, v137 wave_ror:1 row_mask:0x1 bank_mask:0x1
    v_mfma_f32_16x16x32_bf16 v[192:195], v[48:51], v[76:79], v[192:195]
    v_add_f32_dpp v233, v249, v136 wave_ror:1 row_mask:0x1 bank_mask:0x1
    v_add_f32_dpp v228, v139, v138 wave_shr:1 row_mask:0xf bank_mask:0xf
    v_mfma_f32_16x16x32_bf16 v[200:203], v[52:55], v[76:79], v[200:203]
    s_waitcnt lgkmcnt(2)
    buffer_store_dwordx4 v[244:247], v239, s[24:27], s40 offen offset:0 sc1
    v_mfma_f32_16x16x32_bf16 v[208:211], v[56:59], v[76:79], v[208:211]
    v_add_f32_dpp v230, v228, v137 wave_shr:1 row_mask:0xf bank_mask:0xf
    v_mfma_f32_16x16x32_bf16 v[216:219], v[60:63], v[76:79], v[216:219]
    v_mfma_f32_16x16x32_bf16 v[224:227], v[64:67], v[76:79], v[224:227]
    v_add_f32_dpp v233, v230, v136 wave_shr:1 row_mask:0xf bank_mask:0xf
    s_nop 0
    v_mfma_f32_16x16x32_bf16 v[140:143], v[20:23], v[84:87], v[140:143]
    ds_read_b64_tr_b16 v[76:77], v15 offset:2208
    ds_read_b64_tr_b16 v[78:79], v15 offset:2176
    v_mfma_f32_16x16x32_bf16 v[148:151], v[24:27], v[84:87], v[148:151]
    ds_read_b64_tr_b16 v[64:65], v15 offset:2336
    ds_read_b64_tr_b16 v[66:67], v15 offset:2304
    v_mfma_f32_16x16x32_bf16 v[156:159], v[28:31], v[84:87], v[156:159]
    v_cvt_pk_bf16_f32 v235, v232, v233
    v_mfma_f32_16x16x32_bf16 v[164:167], v[32:35], v[84:87], v[164:167]
    v_add_f32_dpp v229, v139, v142 wave_ror:1 row_mask:0x1 bank_mask:0x1
    v_mov_b32_dpp v253, v235 quad_perm:[1,0,3,2] row_mask:0xf bank_mask:0xf
    v_mfma_f32_16x16x32_bf16 v[172:175], v[36:39], v[84:87], v[172:175]
    v_perm_b32 v253, v253, v235, v255
    v_add_f32_dpp v231, v228, v141 wave_ror:1 row_mask:0x1 bank_mask:0x1
    v_mfma_f32_16x16x32_bf16 v[180:183], v[40:43], v[84:87], v[180:183]
    v_add_f32_dpp v250, v230, v140 wave_ror:1 row_mask:0x1 bank_mask:0x1
    v_add_f32_dpp v229, v143, v142 wave_shr:1 row_mask:0xf bank_mask:0xf
    v_mfma_f32_16x16x32_bf16 v[188:191], v[44:47], v[84:87], v[188:191]
    ds_write_b32 v236, v253 offset:1024
    v_mfma_f32_16x16x32_bf16 v[196:199], v[48:51], v[84:87], v[196:199]
    v_add_f32_dpp v231, v229, v141 wave_shr:1 row_mask:0xf bank_mask:0xf
    v_mfma_f32_16x16x32_bf16 v[204:207], v[52:55], v[84:87], v[204:207]
    v_mfma_f32_16x16x32_bf16 v[212:215], v[56:59], v[84:87], v[212:215]
    v_add_f32_dpp v250, v231, v140 wave_shr:1 row_mask:0xf bank_mask:0xf
    v_mfma_f32_16x16x32_bf16 v[220:223], v[60:63], v[84:87], v[220:223]
    s_nop 0
    v_mfma_f32_16x16x32_bf16 v[144:147], v[20:23], v[88:91], v[144:147]
    ds_read_b64_tr_b16 v[84:85], v15 offset:2464
    ds_read_b64_tr_b16 v[86:87], v15 offset:2432
    v_mfma_f32_16x16x32_bf16 v[152:155], v[24:27], v[88:91], v[152:155]
    v_mfma_f32_16x16x32_bf16 v[160:163], v[28:31], v[88:91], v[160:163]
    v_mfma_f32_16x16x32_bf16 v[168:171], v[32:35], v[88:91], v[168:171]
    v_mfma_f32_16x16x32_bf16 v[176:179], v[36:39], v[88:91], v[176:179]
    v_mfma_f32_16x16x32_bf16 v[184:187], v[40:43], v[88:91], v[184:187]
    v_mfma_f32_16x16x32_bf16 v[192:195], v[44:47], v[88:91], v[192:195]
    v_add_f32_dpp v248, v143, v146 wave_ror:1 row_mask:0x1 bank_mask:0x1
    v_add_f32_dpp v249, v229, v145 wave_ror:1 row_mask:0x1 bank_mask:0x1
    v_mfma_f32_16x16x32_bf16 v[200:203], v[48:51], v[88:91], v[200:203]
    v_add_f32_dpp v251, v231, v144 wave_ror:1 row_mask:0x1 bank_mask:0x1
    v_add_f32_dpp v248, v147, v146 wave_shr:1 row_mask:0xf bank_mask:0xf
    v_mfma_f32_16x16x32_bf16 v[208:211], v[52:55], v[88:91], v[208:211]
    v_mfma_f32_16x16x32_bf16 v[216:219], v[56:59], v[88:91], v[216:219]
    v_add_f32_dpp v249, v248, v145 wave_shr:1 row_mask:0xf bank_mask:0xf
    v_mfma_f32_16x16x32_bf16 v[224:227], v[60:63], v[88:91], v[224:227]
    s_nop 0
    v_mfma_f32_16x16x32_bf16 v[148:151], v[20:23], v[72:75], v[148:151]
    ds_read_b64_tr_b16 v[88:89], v15 offset:2592
    ds_read_b64_tr_b16 v[90:91], v15 offset:2560
    v_mfma_f32_16x16x32_bf16 v[156:159], v[24:27], v[72:75], v[156:159]
    ds_read_b64_tr_b16 v[60:61], v15 offset:2720
    ds_read_b64_tr_b16 v[62:63], v15 offset:2688
    v_mfma_f32_16x16x32_bf16 v[164:167], v[28:31], v[72:75], v[164:167]
    v_add_f32_dpp v251, v249, v144 wave_shr:1 row_mask:0xf bank_mask:0xf
    v_mfma_f32_16x16x32_bf16 v[172:175], v[32:35], v[72:75], v[172:175]
    v_cvt_pk_bf16_f32 v252, v250, v251
    v_add_f32_dpp v228, v147, v150 wave_ror:1 row_mask:0x1 bank_mask:0x1
    v_mfma_f32_16x16x32_bf16 v[180:183], v[36:39], v[72:75], v[180:183]
    v_mov_b32_dpp v254, v252 quad_perm:[1,0,3,2] row_mask:0xf bank_mask:0xf
    v_add_f32_dpp v230, v248, v149 wave_ror:1 row_mask:0x1 bank_mask:0x1
    v_mfma_f32_16x16x32_bf16 v[188:191], v[40:43], v[72:75], v[188:191]
    v_perm_b32 v254, v254, v252, v255
    v_add_f32_dpp v232, v249, v148 wave_ror:1 row_mask:0x1 bank_mask:0x1
    v_mfma_f32_16x16x32_bf16 v[196:199], v[44:47], v[72:75], v[196:199]
    v_add_f32_dpp v228, v151, v150 wave_shr:1 row_mask:0xf bank_mask:0xf
    v_mfma_f32_16x16x32_bf16 v[204:207], v[48:51], v[72:75], v[204:207]
    ds_write_b32 v236, v254 offset:1280
    v_mfma_f32_16x16x32_bf16 v[212:215], v[52:55], v[72:75], v[212:215]
    v_add_f32_dpp v230, v228, v149 wave_shr:1 row_mask:0xf bank_mask:0xf
    v_mfma_f32_16x16x32_bf16 v[220:223], v[56:59], v[72:75], v[220:223]
    s_nop 0
    v_mfma_f32_16x16x32_bf16 v[152:155], v[20:23], v[80:83], v[152:155]
    ds_read_b64_tr_b16 v[72:73], v15 offset:2848
    ds_read_b64_tr_b16 v[74:75], v15 offset:2816
    v_mfma_f32_16x16x32_bf16 v[160:163], v[24:27], v[80:83], v[160:163]
    v_add_f32_dpp v232, v230, v148 wave_shr:1 row_mask:0xf bank_mask:0xf
    v_mfma_f32_16x16x32_bf16 v[168:171], v[28:31], v[80:83], v[168:171]
    v_mfma_f32_16x16x32_bf16 v[176:179], v[32:35], v[80:83], v[176:179]
    v_mfma_f32_16x16x32_bf16 v[184:187], v[36:39], v[80:83], v[184:187]
    v_mfma_f32_16x16x32_bf16 v[192:195], v[40:43], v[80:83], v[192:195]
    v_add_f32_dpp v229, v151, v154 wave_ror:1 row_mask:0x1 bank_mask:0x1
    v_add_f32_dpp v231, v228, v153 wave_ror:1 row_mask:0x1 bank_mask:0x1
    v_mfma_f32_16x16x32_bf16 v[200:203], v[44:47], v[80:83], v[200:203]
    v_add_f32_dpp v233, v230, v152 wave_ror:1 row_mask:0x1 bank_mask:0x1
    v_add_f32_dpp v229, v155, v154 wave_shr:1 row_mask:0xf bank_mask:0xf
    v_mfma_f32_16x16x32_bf16 v[208:211], v[48:51], v[80:83], v[208:211]
    v_mfma_f32_16x16x32_bf16 v[216:219], v[52:55], v[80:83], v[216:219]
    v_add_f32_dpp v231, v229, v153 wave_shr:1 row_mask:0xf bank_mask:0xf
    v_mfma_f32_16x16x32_bf16 v[224:227], v[56:59], v[80:83], v[224:227]
    s_nop 0
    v_mfma_f32_16x16x32_bf16 v[156:159], v[20:23], v[92:95], v[156:159]
    ds_read_b64_tr_b16 v[80:81], v15 offset:2976
    ds_read_b64_tr_b16 v[82:83], v15 offset:2944
    v_mfma_f32_16x16x32_bf16 v[164:167], v[24:27], v[92:95], v[164:167]
    ds_read_b64_tr_b16 v[56:57], v15 offset:3104
    ds_read_b64_tr_b16 v[58:59], v15 offset:3072
    v_mfma_f32_16x16x32_bf16 v[172:175], v[28:31], v[92:95], v[172:175]
    v_add_f32_dpp v233, v231, v152 wave_shr:1 row_mask:0xf bank_mask:0xf
    v_mfma_f32_16x16x32_bf16 v[180:183], v[32:35], v[92:95], v[180:183]
    v_cvt_pk_bf16_f32 v235, v232, v233
    v_add_f32_dpp v248, v155, v158 wave_ror:1 row_mask:0x1 bank_mask:0x1
    v_mfma_f32_16x16x32_bf16 v[188:191], v[36:39], v[92:95], v[188:191]
    v_mov_b32_dpp v253, v235 quad_perm:[1,0,3,2] row_mask:0xf bank_mask:0xf
    v_add_f32_dpp v249, v229, v157 wave_ror:1 row_mask:0x1 bank_mask:0x1
    v_mfma_f32_16x16x32_bf16 v[196:199], v[40:43], v[92:95], v[196:199]
    v_perm_b32 v253, v253, v235, v255
    v_add_f32_dpp v250, v231, v156 wave_ror:1 row_mask:0x1 bank_mask:0x1
    v_mfma_f32_16x16x32_bf16 v[204:207], v[44:47], v[92:95], v[204:207]
    v_add_f32_dpp v248, v159, v158 wave_shr:1 row_mask:0xf bank_mask:0xf
    v_mfma_f32_16x16x32_bf16 v[212:215], v[48:51], v[92:95], v[212:215]
    ds_write_b32 v236, v253 offset:1536
    v_mfma_f32_16x16x32_bf16 v[220:223], v[52:55], v[92:95], v[220:223]
    v_add_f32_dpp v249, v248, v157 wave_shr:1 row_mask:0xf bank_mask:0xf
    s_nop 0
    v_mfma_f32_16x16x32_bf16 v[160:163], v[20:23], v[68:71], v[160:163]
    ds_read_b64_tr_b16 v[92:93], v15 offset:3232
    ds_read_b64_tr_b16 v[94:95], v15 offset:3200
    v_mfma_f32_16x16x32_bf16 v[168:171], v[24:27], v[68:71], v[168:171]
    v_add_f32_dpp v250, v249, v156 wave_shr:1 row_mask:0xf bank_mask:0xf
    v_mfma_f32_16x16x32_bf16 v[176:179], v[28:31], v[68:71], v[176:179]
    v_mfma_f32_16x16x32_bf16 v[184:187], v[32:35], v[68:71], v[184:187]
    v_mfma_f32_16x16x32_bf16 v[192:195], v[36:39], v[68:71], v[192:195]
    v_mfma_f32_16x16x32_bf16 v[200:203], v[40:43], v[68:71], v[200:203]
    v_add_f32_dpp v228, v159, v162 wave_ror:1 row_mask:0x1 bank_mask:0x1
    v_add_f32_dpp v230, v248, v161 wave_ror:1 row_mask:0x1 bank_mask:0x1
    v_mfma_f32_16x16x32_bf16 v[208:211], v[44:47], v[68:71], v[208:211]
    v_add_f32_dpp v251, v249, v160 wave_ror:1 row_mask:0x1 bank_mask:0x1
    v_add_f32_dpp v228, v163, v162 wave_shr:1 row_mask:0xf bank_mask:0xf
    v_mfma_f32_16x16x32_bf16 v[216:219], v[48:51], v[68:71], v[216:219]
    v_mfma_f32_16x16x32_bf16 v[224:227], v[52:55], v[68:71], v[224:227]
    v_add_f32_dpp v230, v228, v161 wave_shr:1 row_mask:0xf bank_mask:0xf
    s_waitcnt lgkmcnt(15)
    v_mfma_f32_16x16x32_bf16 v[164:167], v[20:23], v[96:99], v[164:167]
    ds_read_b64_tr_b16 v[68:69], v15 offset:3360
    ds_read_b64_tr_b16 v[70:71], v15 offset:3328
    v_mfma_f32_16x16x32_bf16 v[172:175], v[24:27], v[96:99], v[172:175]
    ds_read_b64_tr_b16 v[52:53], v15 offset:3488
    ds_read_b64_tr_b16 v[54:55], v15 offset:3456
    v_mfma_f32_16x16x32_bf16 v[180:183], v[28:31], v[96:99], v[180:183]
    v_add_f32_dpp v251, v230, v160 wave_shr:1 row_mask:0xf bank_mask:0xf
    v_mfma_f32_16x16x32_bf16 v[188:191], v[32:35], v[96:99], v[188:191]
    v_cvt_pk_bf16_f32 v252, v250, v251
    v_add_f32_dpp v229, v163, v166 wave_ror:1 row_mask:0x1 bank_mask:0x1
    v_mfma_f32_16x16x32_bf16 v[196:199], v[36:39], v[96:99], v[196:199]
    v_mov_b32_dpp v254, v252 quad_perm:[1,0,3,2] row_mask:0xf bank_mask:0xf
    v_add_f32_dpp v231, v228, v165 wave_ror:1 row_mask:0x1 bank_mask:0x1
    v_mfma_f32_16x16x32_bf16 v[204:207], v[40:43], v[96:99], v[204:207]
    v_perm_b32 v254, v254, v252, v255
    v_add_f32_dpp v232, v230, v164 wave_ror:1 row_mask:0x1 bank_mask:0x1
    v_mfma_f32_16x16x32_bf16 v[212:215], v[44:47], v[96:99], v[212:215]
    v_add_f32_dpp v229, v167, v166 wave_shr:1 row_mask:0xf bank_mask:0xf
    v_mfma_f32_16x16x32_bf16 v[220:223], v[48:51], v[96:99], v[220:223]
    ds_write_b32 v236, v254 offset:1792
    s_nop 0
    v_mfma_f32_16x16x32_bf16 v[168:171], v[20:23], v[76:79], v[168:171]
    ds_read_b64_tr_b16 v[96:97], v15 offset:3616
    ds_read_b64_tr_b16 v[98:99], v15 offset:3584
    v_mfma_f32_16x16x32_bf16 v[176:179], v[24:27], v[76:79], v[176:179]
    ds_read_b128 v[244:247], v243 offset:1024
    v_add_f32_dpp v231, v229, v165 wave_shr:1 row_mask:0xf bank_mask:0xf
    v_mfma_f32_16x16x32_bf16 v[184:187], v[28:31], v[76:79], v[184:187]
    v_mfma_f32_16x16x32_bf16 v[192:195], v[32:35], v[76:79], v[192:195]
    v_add_f32_dpp v232, v231, v164 wave_shr:1 row_mask:0xf bank_mask:0xf
    v_add_f32_dpp v248, v167, v170 wave_ror:1 row_mask:0x1 bank_mask:0x1
    v_mfma_f32_16x16x32_bf16 v[200:203], v[36:39], v[76:79], v[200:203]
    v_add_f32_dpp v249, v229, v169 wave_ror:1 row_mask:0x1 bank_mask:0x1
    v_add_f32_dpp v233, v231, v168 wave_ror:1 row_mask:0x1 bank_mask:0x1
    v_mfma_f32_16x16x32_bf16 v[208:211], v[40:43], v[76:79], v[208:211]
    v_add_f32_dpp v248, v171, v170 wave_shr:1 row_mask:0xf bank_mask:0xf
    v_mfma_f32_16x16x32_bf16 v[216:219], v[44:47], v[76:79], v[216:219]
    v_mfma_f32_16x16x32_bf16 v[224:227], v[48:51], v[76:79], v[224:227]
    v_add_f32_dpp v249, v248, v169 wave_shr:1 row_mask:0xf bank_mask:0xf
    s_nop 0
    v_mfma_f32_16x16x32_bf16 v[172:175], v[20:23], v[64:67], v[172:175]
    ds_read_b64_tr_b16 v[76:77], v15 offset:3744
    ds_read_b64_tr_b16 v[78:79], v15 offset:3712
    v_mfma_f32_16x16x32_bf16 v[180:183], v[24:27], v[64:67], v[180:183]
    ds_read_b64_tr_b16 v[48:49], v15 offset:3872
    ds_read_b64_tr_b16 v[50:51], v15 offset:3840
    v_mfma_f32_16x16x32_bf16 v[188:191], v[28:31], v[64:67], v[188:191]
    v_add_f32_dpp v233, v249, v168 wave_shr:1 row_mask:0xf bank_mask:0xf
    v_mfma_f32_16x16x32_bf16 v[196:199], v[32:35], v[64:67], v[196:199]
    s_waitcnt lgkmcnt(4)
    buffer_store_dwordx4 v[244:247], v239, s[24:27], s40 offen offset:1024 sc1
    v_mfma_f32_16x16x32_bf16 v[204:207], v[36:39], v[64:67], v[204:207]
    v_cvt_pk_bf16_f32 v235, v232, v233
    v_add_f32_dpp v228, v171, v174 wave_ror:1 row_mask:0x1 bank_mask:0x1
    v_mfma_f32_16x16x32_bf16 v[212:215], v[40:43], v[64:67], v[212:215]
    v_mov_b32_dpp v253, v235 quad_perm:[1,0,3,2] row_mask:0xf bank_mask:0xf
    v_add_f32_dpp v230, v248, v173 wave_ror:1 row_mask:0x1 bank_mask:0x1
    v_mfma_f32_16x16x32_bf16 v[220:223], v[44:47], v[64:67], v[220:223]
    v_perm_b32 v253, v253, v235, v255
    v_add_f32_dpp v250, v249, v172 wave_ror:1 row_mask:0x1 bank_mask:0x1
    s_nop 0
    v_mfma_f32_16x16x32_bf16 v[176:179], v[20:23], v[84:87], v[176:179]
    ds_read_b64_tr_b16 v[64:65], v15 offset:4000
    ds_read_b64_tr_b16 v[66:67], v15 offset:3968
    v_mfma_f32_16x16x32_bf16 v[184:187], v[24:27], v[84:87], v[184:187]
    ds_write_b32 v236, v253 offset:2048
    v_mfma_f32_16x16x32_bf16 v[192:195], v[28:31], v[84:87], v[192:195]
    v_add_f32_dpp v228, v175, v174 wave_shr:1 row_mask:0xf bank_mask:0xf
    v_mfma_f32_16x16x32_bf16 v[200:203], v[32:35], v[84:87], v[200:203]
    v_mfma_f32_16x16x32_bf16 v[208:211], v[36:39], v[84:87], v[208:211]
    v_add_f32_dpp v230, v228, v173 wave_shr:1 row_mask:0xf bank_mask:0xf
    v_add_f32_dpp v229, v175, v178 wave_ror:1 row_mask:0x1 bank_mask:0x1
    v_mfma_f32_16x16x32_bf16 v[216:219], v[40:43], v[84:87], v[216:219]
    v_add_f32_dpp v250, v230, v172 wave_shr:1 row_mask:0xf bank_mask:0xf
    v_add_f32_dpp v231, v228, v177 wave_ror:1 row_mask:0x1 bank_mask:0x1
    v_mfma_f32_16x16x32_bf16 v[224:227], v[44:47], v[84:87], v[224:227]
    v_add_f32_dpp v251, v230, v176 wave_ror:1 row_mask:0x1 bank_mask:0x1
    v_add_f32_dpp v229, v179, v178 wave_shr:1 row_mask:0xf bank_mask:0xf
    s_nop 0
    v_mfma_f32_16x16x32_bf16 v[180:183], v[20:23], v[88:91], v[180:183]
    v_add_f32_dpp v231, v229, v177 wave_shr:1 row_mask:0xf bank_mask:0xf
    v_mfma_f32_16x16x32_bf16 v[188:191], v[24:27], v[88:91], v[188:191]
    v_mfma_f32_16x16x32_bf16 v[196:199], v[28:31], v[88:91], v[196:199]
    v_add_f32_dpp v251, v231, v176 wave_shr:1 row_mask:0xf bank_mask:0xf
    v_mfma_f32_16x16x32_bf16 v[204:207], v[32:35], v[88:91], v[204:207]
    v_cvt_pk_bf16_f32 v252, v250, v251
    v_mfma_f32_16x16x32_bf16 v[212:215], v[36:39], v[88:91], v[212:215]
    v_mfma_f32_16x16x32_bf16 v[220:223], v[40:43], v[88:91], v[220:223]
    v_mov_b32_dpp v254, v252 quad_perm:[1,0,3,2] row_mask:0xf bank_mask:0xf
    v_add_f32_dpp v248, v179, v182 wave_ror:1 row_mask:0x1 bank_mask:0x1
    s_nop 0
    v_mfma_f32_16x16x32_bf16 v[184:187], v[20:23], v[60:63], v[184:187]
    v_perm_b32 v254, v254, v252, v255
    v_add_f32_dpp v249, v229, v181 wave_ror:1 row_mask:0x1 bank_mask:0x1
    v_mfma_f32_16x16x32_bf16 v[192:195], v[24:27], v[60:63], v[192:195]
    v_add_f32_dpp v232, v231, v180 wave_ror:1 row_mask:0x1 bank_mask:0x1
    v_add_f32_dpp v248, v183, v182 wave_shr:1 row_mask:0xf bank_mask:0xf
    v_mfma_f32_16x16x32_bf16 v[200:203], v[28:31], v[60:63], v[200:203]
    ds_write_b32 v236, v254 offset:2304
    v_mfma_f32_16x16x32_bf16 v[208:211], v[32:35], v[60:63], v[208:211]
    v_add_f32_dpp v249, v248, v181 wave_shr:1 row_mask:0xf bank_mask:0xf
    v_add_f32_dpp v228, v183, v186 wave_ror:1 row_mask:0x1 bank_mask:0x1
    v_mfma_f32_16x16x32_bf16 v[216:219], v[36:39], v[60:63], v[216:219]
    v_add_f32_dpp v232, v249, v180 wave_shr:1 row_mask:0xf bank_mask:0xf
    v_add_f32_dpp v230, v248, v185 wave_ror:1 row_mask:0x1 bank_mask:0x1
    v_mfma_f32_16x16x32_bf16 v[224:227], v[40:43], v[60:63], v[224:227]
    v_add_f32_dpp v233, v249, v184 wave_ror:1 row_mask:0x1 bank_mask:0x1
    v_add_f32_dpp v228, v187, v186 wave_shr:1 row_mask:0xf bank_mask:0xf
    s_nop 0
    v_mfma_f32_16x16x32_bf16 v[188:191], v[20:23], v[72:75], v[188:191]
    v_add_f32_dpp v230, v228, v185 wave_shr:1 row_mask:0xf bank_mask:0xf
    v_mfma_f32_16x16x32_bf16 v[196:199], v[24:27], v[72:75], v[196:199]
    v_mfma_f32_16x16x32_bf16 v[204:207], v[28:31], v[72:75], v[204:207]
    v_add_f32_dpp v233, v230, v184 wave_shr:1 row_mask:0xf bank_mask:0xf
    v_mfma_f32_16x16x32_bf16 v[212:215], v[32:35], v[72:75], v[212:215]
    v_cvt_pk_bf16_f32 v235, v232, v233
    v_mfma_f32_16x16x32_bf16 v[220:223], v[36:39], v[72:75], v[220:223]
    s_nop 0
    v_mfma_f32_16x16x32_bf16 v[192:195], v[20:23], v[80:83], v[192:195]
    v_mov_b32_dpp v253, v235 quad_perm:[1,0,3,2] row_mask:0xf bank_mask:0xf
    v_add_f32_dpp v229, v187, v190 wave_ror:1 row_mask:0x1 bank_mask:0x1
    v_mfma_f32_16x16x32_bf16 v[200:203], v[24:27], v[80:83], v[200:203]
    v_perm_b32 v253, v253, v235, v255
    v_add_f32_dpp v231, v228, v189 wave_ror:1 row_mask:0x1 bank_mask:0x1
    v_mfma_f32_16x16x32_bf16 v[208:211], v[28:31], v[80:83], v[208:211]
    v_add_f32_dpp v250, v230, v188 wave_ror:1 row_mask:0x1 bank_mask:0x1
    v_add_f32_dpp v229, v191, v190 wave_shr:1 row_mask:0xf bank_mask:0xf
    v_mfma_f32_16x16x32_bf16 v[216:219], v[32:35], v[80:83], v[216:219]
    ds_write_b32 v236, v253 offset:2560
    v_mfma_f32_16x16x32_bf16 v[224:227], v[36:39], v[80:83], v[224:227]
    v_add_f32_dpp v231, v229, v189 wave_shr:1 row_mask:0xf bank_mask:0xf
    v_add_f32_dpp v248, v191, v194 wave_ror:1 row_mask:0x1 bank_mask:0x1
    s_nop 0
    v_mfma_f32_16x16x32_bf16 v[196:199], v[20:23], v[56:59], v[196:199]
    v_add_f32_dpp v250, v231, v188 wave_shr:1 row_mask:0xf bank_mask:0xf
    v_add_f32_dpp v249, v229, v193 wave_ror:1 row_mask:0x1 bank_mask:0x1
    v_mfma_f32_16x16x32_bf16 v[204:207], v[24:27], v[56:59], v[204:207]
    v_add_f32_dpp v251, v231, v192 wave_ror:1 row_mask:0x1 bank_mask:0x1
    v_add_f32_dpp v248, v195, v194 wave_shr:1 row_mask:0xf bank_mask:0xf
    v_mfma_f32_16x16x32_bf16 v[212:215], v[28:31], v[56:59], v[212:215]
    v_mfma_f32_16x16x32_bf16 v[220:223], v[32:35], v[56:59], v[220:223]
    v_add_f32_dpp v249, v248, v193 wave_shr:1 row_mask:0xf bank_mask:0xf
    v_add_f32_dpp v228, v195, v198 wave_ror:1 row_mask:0x1 bank_mask:0x1
    s_nop 0
    v_mfma_f32_16x16x32_bf16 v[200:203], v[20:23], v[92:95], v[200:203]
    v_add_f32_dpp v251, v249, v192 wave_shr:1 row_mask:0xf bank_mask:0xf
    v_add_f32_dpp v230, v248, v197 wave_ror:1 row_mask:0x1 bank_mask:0x1
    v_mfma_f32_16x16x32_bf16 v[208:211], v[24:27], v[92:95], v[208:211]
    v_cvt_pk_bf16_f32 v252, v250, v251
    v_add_f32_dpp v232, v249, v196 wave_ror:1 row_mask:0x1 bank_mask:0x1
    v_mfma_f32_16x16x32_bf16 v[216:219], v[28:31], v[92:95], v[216:219]
    v_mov_b32_dpp v254, v252 quad_perm:[1,0,3,2] row_mask:0xf bank_mask:0xf
    v_add_f32_dpp v228, v199, v198 wave_shr:1 row_mask:0xf bank_mask:0xf
    v_mfma_f32_16x16x32_bf16 v[224:227], v[32:35], v[92:95], v[224:227]
    v_perm_b32 v254, v254, v252, v255
    v_add_f32_dpp v230, v228, v197 wave_shr:1 row_mask:0xf bank_mask:0xf
    s_nop 0
    v_mfma_f32_16x16x32_bf16 v[204:207], v[20:23], v[68:71], v[204:207]
    ds_write_b32 v236, v254 offset:2816
    v_mfma_f32_16x16x32_bf16 v[212:215], v[24:27], v[68:71], v[212:215]
    ds_read_b128 v[244:247], v243 offset:2048
    v_add_f32_dpp v232, v230, v196 wave_shr:1 row_mask:0xf bank_mask:0xf
    v_mfma_f32_16x16x32_bf16 v[220:223], v[28:31], v[68:71], v[220:223]
    v_add_f32_dpp v229, v199, v202 wave_ror:1 row_mask:0x1 bank_mask:0x1
    v_add_f32_dpp v231, v228, v201 wave_ror:1 row_mask:0x1 bank_mask:0x1
    s_nop 0
    v_mfma_f32_16x16x32_bf16 v[208:211], v[20:23], v[52:55], v[208:211]
    v_add_f32_dpp v233, v230, v200 wave_ror:1 row_mask:0x1 bank_mask:0x1
    v_add_f32_dpp v229, v203, v202 wave_shr:1 row_mask:0xf bank_mask:0xf
    v_mfma_f32_16x16x32_bf16 v[216:219], v[24:27], v[52:55], v[216:219]
    v_add_f32_dpp v248, v203, v206 wave_ror:1 row_mask:0x1 bank_mask:0x1
    v_add_f32_dpp v231, v229, v201 wave_shr:1 row_mask:0xf bank_mask:0xf
    v_mfma_f32_16x16x32_bf16 v[224:227], v[28:31], v[52:55], v[224:227]
    v_add_f32_dpp v249, v229, v205 wave_ror:1 row_mask:0x1 bank_mask:0x1
    v_add_f32_dpp v233, v231, v200 wave_shr:1 row_mask:0xf bank_mask:0xf
    s_nop 0
    v_mfma_f32_16x16x32_bf16 v[212:215], v[20:23], v[96:99], v[212:215]
    v_cvt_pk_bf16_f32 v235, v232, v233
    v_add_f32_dpp v250, v231, v204 wave_ror:1 row_mask:0x1 bank_mask:0x1
    v_mfma_f32_16x16x32_bf16 v[220:223], v[24:27], v[96:99], v[220:223]
    v_mov_b32_dpp v253, v235 quad_perm:[1,0,3,2] row_mask:0xf bank_mask:0xf
    v_add_f32_dpp v248, v207, v206 wave_shr:1 row_mask:0xf bank_mask:0xf
    s_waitcnt lgkmcnt(9)
    v_mfma_f32_16x16x32_bf16 v[216:219], v[20:23], v[76:79], v[216:219]
    s_waitcnt lgkmcnt(0)
    buffer_store_dwordx4 v[244:247], v239, s[24:27], s40 offen offset:2048 sc1
    v_mfma_f32_16x16x32_bf16 v[224:227], v[24:27], v[76:79], v[224:227]
    v_perm_b32 v253, v253, v235, v255
    v_add_f32_dpp v249, v248, v205 wave_shr:1 row_mask:0xf bank_mask:0xf
    s_nop 0
    v_mfma_f32_16x16x32_bf16 v[220:223], v[20:23], v[48:51], v[220:223]
    ds_write_b32 v236, v253 offset:3072
    s_nop 0
    v_mfma_f32_16x16x32_bf16 v[224:227], v[20:23], v[64:67], v[224:227]
    v_add_f32_dpp v250, v249, v204 wave_shr:1 row_mask:0xf bank_mask:0xf
    v_add_f32_dpp v228, v207, v210 wave_ror:1 row_mask:0x1 bank_mask:0x1
    v_add_f32_dpp v230, v248, v209 wave_ror:1 row_mask:0x1 bank_mask:0x1
    v_add_f32_dpp v251, v249, v208 wave_ror:1 row_mask:0x1 bank_mask:0x1
    v_add_f32_dpp v228, v211, v210 wave_shr:1 row_mask:0xf bank_mask:0xf
    v_add_f32_dpp v229, v211, v214 wave_ror:1 row_mask:0x1 bank_mask:0x1
    v_add_f32_dpp v248, v215, v218 wave_ror:1 row_mask:0x1 bank_mask:0x1
    v_add_f32_dpp v230, v228, v209 wave_shr:1 row_mask:0xf bank_mask:0xf
    v_add_f32_dpp v231, v228, v213 wave_ror:1 row_mask:0x1 bank_mask:0x1
    v_add_f32_dpp v229, v215, v214 wave_shr:1 row_mask:0xf bank_mask:0xf
    v_add_f32_dpp v251, v230, v208 wave_shr:1 row_mask:0xf bank_mask:0xf
    v_add_f32_dpp v232, v230, v212 wave_ror:1 row_mask:0x1 bank_mask:0x1
    v_cvt_pk_bf16_f32 v252, v250, v251
    v_add_f32_dpp v231, v229, v213 wave_shr:1 row_mask:0xf bank_mask:0xf
    v_add_f32_dpp v249, v229, v217 wave_ror:1 row_mask:0x1 bank_mask:0x1
    v_mov_b32_dpp v254, v252 quad_perm:[1,0,3,2] row_mask:0xf bank_mask:0xf
    v_add_f32_dpp v232, v231, v212 wave_shr:1 row_mask:0xf bank_mask:0xf
    v_perm_b32 v254, v254, v252, v255
    v_add_f32_dpp v233, v231, v216 wave_ror:1 row_mask:0x1 bank_mask:0x1
    v_add_f32_dpp v248, v219, v218 wave_shr:1 row_mask:0xf bank_mask:0xf
    v_add_f32_dpp v228, v219, v222 wave_ror:1 row_mask:0x1 bank_mask:0x1
    v_add_f32_dpp v229, v223, v226 wave_ror:1 row_mask:0x1 bank_mask:0x1
    ds_write_b32 v236, v254 offset:3328
    v_add_f32_dpp v249, v248, v217 wave_shr:1 row_mask:0xf bank_mask:0xf
    v_add_f32_dpp v230, v248, v221 wave_ror:1 row_mask:0x1 bank_mask:0x1
    v_add_f32_dpp v228, v223, v222 wave_shr:1 row_mask:0xf bank_mask:0xf
    v_add_f32_dpp v233, v249, v216 wave_shr:1 row_mask:0xf bank_mask:0xf
    v_add_f32_dpp v250, v249, v220 wave_ror:1 row_mask:0x1 bank_mask:0x1
    v_cvt_pk_bf16_f32 v235, v232, v233
    v_add_f32_dpp v230, v228, v221 wave_shr:1 row_mask:0xf bank_mask:0xf
    v_add_f32_dpp v231, v228, v225 wave_ror:1 row_mask:0x1 bank_mask:0x1
    v_mov_b32_dpp v253, v235 quad_perm:[1,0,3,2] row_mask:0xf bank_mask:0xf
    v_add_f32_dpp v250, v230, v220 wave_shr:1 row_mask:0xf bank_mask:0xf
    v_perm_b32 v253, v253, v235, v255
    v_add_f32_dpp v251, v230, v224 wave_ror:1 row_mask:0x1 bank_mask:0x1
    v_add_f32_dpp v229, v227, v226 wave_shr:1 row_mask:0xf bank_mask:0xf
    s_nop 0
    ds_write_b32 v236, v253 offset:3584
    v_add_f32_dpp v231, v229, v225 wave_shr:1 row_mask:0xf bank_mask:0xf
    s_nop 0
    s_nop 0
    v_add_f32_dpp v251, v231, v224 wave_shr:1 row_mask:0xf bank_mask:0xf
    s_nop 0
    v_cvt_pk_bf16_f32 v252, v250, v251
    s_nop 0
    s_nop 0
    v_mov_b32_dpp v254, v252 quad_perm:[1,0,3,2] row_mask:0xf bank_mask:0xf
    s_nop 0
    v_perm_b32 v254, v254, v252, v255
    s_nop 0
    s_nop 0
    s_nop 0
    ds_write_b32 v236, v254 offset:3840
    s_setprio 1
    s_waitcnt lgkmcnt(0)
    ds_read_b128 v[32:35], v243 offset:3072
    s_waitcnt lgkmcnt(0)
    buffer_store_dwordx4 v[32:35], v239, s[24:27], s40 offen offset:3072 sc1
    v_lshlrev_b32 v5, 11, v240
    v_lshl_add_u32 v5, v241, 1, v5
    v_add_u32 v9, 4096, v5
    v_add_u32 v10, 8192, v5
    v_add_u32 v11, 12288, v5
    buffer_load_dwordx2 v[40:41], v5, s[28:31], 0 offen
    buffer_load_dwordx2 v[42:43], v5, s[28:31], 0 offen offset:2048
    buffer_load_dwordx2 v[44:45], v9, s[28:31], 0 offen
    buffer_load_dwordx2 v[46:47], v9, s[28:31], 0 offen offset:2048
    buffer_load_dwordx2 v[48:49], v10, s[28:31], 0 offen
    buffer_load_dwordx2 v[50:51], v10, s[28:31], 0 offen offset:2048
    buffer_load_dwordx2 v[52:53], v11, s[28:31], 0 offen
    buffer_load_dwordx2 v[54:55], v11, s[28:31], 0 offen offset:2048
    v_lshlrev_b32 v13, 12, v241
    v_lshl_add_u32 v13, v240, 1, v13
    v_lshlrev_b32 v6, 12, v240
    v_lshl_add_u32 v6, v241, 1, v6
    v_add_u32 v12, 24576, v242
    s_waitcnt vmcnt(8)
    v_mov_b32 v7, 66832
    v_mov_b32 v8, 1
    s_mov_b64 exec, 1
    ds_add_rtn_u32 v8, v7, v8
    s_waitcnt lgkmcnt(0)
    s_mov_b64 exec, -1
    v_readfirstlane_b32 s80, v8
    s_nop 3
    s_cmp_eq_u32 s80, 3
    s_cbranch_scc0 e29
    s_mov_b64 exec, 1
    buffer_store_dword v237, v12, s[44:47], 0 offen
    buffer_store_dword v237, v242, s[44:47], 0 offen sc1
    s_mov_b64 exec, -1
e29:
    s_cmp_eq_u32 s3, 0
    s_cbranch_scc0 wp10_spin
    s_mov_b32 s80, 0
pt11:
    buffer_load_dword v7, v238, s[44:47], 0 offen nt
    s_waitcnt vmcnt(0)
    v_cmp_ne_u32 vcc, v7, v237
    s_nop 4
    s_cbranch_vccz pt11_ok
    s_add_u32 s80, s80, 1
    s_and_b32 s81, s80, 3
    s_cmp_eq_u32 s81, 0
    s_cbranch_scc1 pt11_glob
    s_sleep 1
    s_branch pt11
pt11_glob:
    s_cmp_gt_u32 s80, 0x80000
    s_cbranch_scc1 pt11_ok
    v_subrev_u32 v8, 24576, v238
    buffer_load_dword v7, v8, s[44:47], 0 offen sc1
    s_waitcnt vmcnt(0)
    v_cmp_ne_u32 vcc, v7, v237
    s_nop 4
    s_cbranch_vccnz pt11
pt11_ok:
    v_mov_b32 v7, 66840
    v_mov_b32 v8, 1
    ds_write_b32 v7, v8
    s_branch wp10_done
wp10_spin:
    v_mov_b32 v7, 66840
    s_mov_b32 s81, 0
spin12:
    ds_read_b32 v8, v7
    s_waitcnt lgkmcnt(0)
    v_readfirstlane_b32 s80, v8
    s_add_u32 s81, s81, 1
    s_cmp_gt_u32 s81, 0x1000000
    s_cbranch_scc1 spin12_ok
    s_nop 0
    s_cmp_ge_u32 s80, 1
    s_cbranch_scc1 spin12_ok
    s_sleep 1
    s_branch spin12
spin12_ok:
wp10_done:
    s_mov_b32 s77, 4096
    s_mov_b32 s78, 8192
    s_mov_b32 s79, 12288
    buffer_load_dwordx4 v[60:63], v13, s[24:27], 0 offen
    buffer_load_dwordx4 v[64:67], v13, s[24:27], s77 offen
    buffer_load_dwordx4 v[68:71], v13, s[24:27], s78 offen
    buffer_load_dwordx4 v[72:75], v13, s[24:27], s79 offen
    s_waitcnt vmcnt(0)
    v_lshlrev_b32 v80, 16, v40
    v_lshlrev_b32 v84, 16, v60
    v_and_b32 v81, s76, v40
    v_lshlrev_b32 v85, 16, v64
    v_lshlrev_b32 v82, 16, v41
    v_lshlrev_b32 v86, 16, v68
    v_and_b32 v83, s76, v41
    v_lshlrev_b32 v87, 16, v72
    v_pk_mul_f32 v[80:81], v[80:81], v[84:85]
    v_pk_mul_f32 v[82:83], v[82:83], v[86:87]
    v_cvt_pk_bf16_f32 v100, v80, v81
    v_cvt_pk_bf16_f32 v101, v82, v83
    buffer_store_dwordx2 v[100:101], v6, s[32:35], 0 offen
    v_lshlrev_b32 v88, 16, v42
    v_and_b32 v92, s76, v60
    v_and_b32 v89, s76, v42
    v_and_b32 v93, s76, v64
    v_lshlrev_b32 v90, 16, v43
    v_and_b32 v94, s76, v68
    v_and_b32 v91, s76, v43
    v_and_b32 v95, s76, v72
    v_pk_mul_f32 v[88:89], v[88:89], v[92:93]
    v_pk_mul_f32 v[90:91], v[90:91], v[94:95]
    v_cvt_pk_bf16_f32 v102, v88, v89
    v_cvt_pk_bf16_f32 v103, v90, v91
    s_mov_b32 s80, 4096
    buffer_store_dwordx2 v[102:103], v6, s[32:35], s80 offen
    v_lshlrev_b32 v80, 16, v44
    v_lshlrev_b32 v84, 16, v61
    v_and_b32 v81, s76, v44
    v_lshlrev_b32 v85, 16, v65
    v_lshlrev_b32 v82, 16, v45
    v_lshlrev_b32 v86, 16, v69
    v_and_b32 v83, s76, v45
    v_lshlrev_b32 v87, 16, v73
    v_pk_mul_f32 v[80:81], v[80:81], v[84:85]
    v_pk_mul_f32 v[82:83], v[82:83], v[86:87]
    v_cvt_pk_bf16_f32 v104, v80, v81
    v_cvt_pk_bf16_f32 v105, v82, v83
    s_mov_b32 s80, 8192
    buffer_store_dwordx2 v[104:105], v6, s[32:35], s80 offen
    v_lshlrev_b32 v88, 16, v46
    v_and_b32 v92, s76, v61
    v_and_b32 v89, s76, v46
    v_and_b32 v93, s76, v65
    v_lshlrev_b32 v90, 16, v47
    v_and_b32 v94, s76, v69
    v_and_b32 v91, s76, v47
    v_and_b32 v95, s76, v73
    v_pk_mul_f32 v[88:89], v[88:89], v[92:93]
    v_pk_mul_f32 v[90:91], v[90:91], v[94:95]
    v_cvt_pk_bf16_f32 v106, v88, v89
    v_cvt_pk_bf16_f32 v107, v90, v91
    s_mov_b32 s80, 12288
    buffer_store_dwordx2 v[106:107], v6, s[32:35], s80 offen
    v_lshlrev_b32 v80, 16, v48
    v_lshlrev_b32 v84, 16, v62
    v_and_b32 v81, s76, v48
    v_lshlrev_b32 v85, 16, v66
    v_lshlrev_b32 v82, 16, v49
    v_lshlrev_b32 v86, 16, v70
    v_and_b32 v83, s76, v49
    v_lshlrev_b32 v87, 16, v74
    v_pk_mul_f32 v[80:81], v[80:81], v[84:85]
    v_pk_mul_f32 v[82:83], v[82:83], v[86:87]
    v_cvt_pk_bf16_f32 v108, v80, v81
    v_cvt_pk_bf16_f32 v109, v82, v83
    s_mov_b32 s80, 16384
    buffer_store_dwordx2 v[108:109], v6, s[32:35], s80 offen
    v_lshlrev_b32 v88, 16, v50
    v_and_b32 v92, s76, v62
    v_and_b32 v89, s76, v50
    v_and_b32 v93, s76, v66
    v_lshlrev_b32 v90, 16, v51
    v_and_b32 v94, s76, v70
    v_and_b32 v91, s76, v51
    v_and_b32 v95, s76, v74
    v_pk_mul_f32 v[88:89], v[88:89], v[92:93]
    v_pk_mul_f32 v[90:91], v[90:91], v[94:95]
    v_cvt_pk_bf16_f32 v110, v88, v89
    v_cvt_pk_bf16_f32 v111, v90, v91
    s_mov_b32 s80, 20480
    buffer_store_dwordx2 v[110:111], v6, s[32:35], s80 offen
    v_lshlrev_b32 v80, 16, v52
    v_lshlrev_b32 v84, 16, v63
    v_and_b32 v81, s76, v52
    v_lshlrev_b32 v85, 16, v67
    v_lshlrev_b32 v82, 16, v53
    v_lshlrev_b32 v86, 16, v71
    v_and_b32 v83, s76, v53
    v_lshlrev_b32 v87, 16, v75
    v_pk_mul_f32 v[80:81], v[80:81], v[84:85]
    v_pk_mul_f32 v[82:83], v[82:83], v[86:87]
    v_cvt_pk_bf16_f32 v112, v80, v81
    v_cvt_pk_bf16_f32 v113, v82, v83
    s_mov_b32 s80, 24576
    buffer_store_dwordx2 v[112:113], v6, s[32:35], s80 offen
    v_lshlrev_b32 v88, 16, v54
    v_and_b32 v92, s76, v63
    v_and_b32 v89, s76, v54
    v_and_b32 v93, s76, v67
    v_lshlrev_b32 v90, 16, v55
    v_and_b32 v94, s76, v71
    v_and_b32 v91, s76, v55
    v_and_b32 v95, s76, v75
    v_pk_mul_f32 v[88:89], v[88:89], v[92:93]
    v_pk_mul_f32 v[90:91], v[90:91], v[94:95]
    v_cvt_pk_bf16_f32 v114, v88, v89
    v_cvt_pk_bf16_f32 v115, v90, v91
    s_mov_b32 s80, 28672
    buffer_store_dwordx2 v[114:115], v6, s[32:35], s80 offen
    s_endpgm
main_exit:
    s_endpgm
text_end:
.section .rodata,"a"
.p2align 6
.amdhsa_kernel concat_heads__ssm_conv_h3__spectral_fnet__prompt_kernel
  .amdhsa_next_free_vgpr 256
  .amdhsa_next_free_sgpr 102
  .amdhsa_accum_offset 256
  .amdhsa_group_segment_fixed_size 0
  .amdhsa_kernarg_size 112
  .amdhsa_user_sgpr_count 2
  .amdhsa_user_sgpr_kernarg_segment_ptr 1
  .amdhsa_system_sgpr_workgroup_id_x 1
  .amdhsa_float_denorm_mode_32 3
.end_amdhsa_kernel
```
